```python
import torch

def _softmax(x, axis=-1):
    return torch.softmax(x, dim=axis)
def _gelu(x):
    return torch.nn.functional.gelu(x, approximate="tanh")
def _silu(x):
    return torch.nn.functional.silu(x)
def _sigmoid(x):
    return torch.sigmoid(x)
def _layernorm(x, axis=-1, eps=1e-5):
    m = x.mean(dim=axis, keepdim=True)
    v = x.var(dim=axis, keepdim=True, unbiased=False)
    return (x - m) / torch.sqrt(v + eps)
def _scatter_add(tgt, idx, src, axis=0):
    return tgt.clone().index_add_(axis, idx, src)
def _segment_sum(src, seg, n):
    out = torch.zeros((n,) + src.shape[1:], dtype=src.dtype)
    return out.index_add_(0, seg, src)
def _pad(x, pw):
    flat = tuple(v for pair in reversed(pw) for v in pair)
    return torch.nn.functional.pad(x, flat)

kernel_name = 'recurrent_scan__linear_attn_block__dense_activation_silu__prompt'

def setup_inputs():

    _w = (lambda a: (lambda t: t.to(torch.bfloat16) if t.is_floating_point() else t)(torch.as_tensor(a)))
    def _A_setup():
        B, S, D = 1, 2048, 448
        return {
            "x": _w((lambda *s: torch.randn(*s, dtype=torch.bfloat16) * 0.05)(B, S, D)),
            "wqkv": _w((lambda *s: torch.randn(*s, dtype=torch.bfloat16) * 0.2)(D, 3 * D)),
            "wo": _w((lambda *s: torch.randn(*s, dtype=torch.bfloat16) * 0.2)(D, D)),
        }
    _A_in = _A_setup()

    def _B_setup():
        B, S, D, F = 1, 2048, 448, 1792
        return {
            "x": _w((lambda *s: torch.randn(*s, dtype=torch.bfloat16) * 0.05)(B, S, D)),
            "w1": _w((lambda *s: torch.randn(*s, dtype=torch.bfloat16) * 0.8)(D, F) * (D ** -0.5)),
            "w2": _w((lambda *s: torch.randn(*s, dtype=torch.bfloat16) * 0.1)(F, D) * (F ** -0.5)),
        }
    _B_in = _B_setup()

    return {
        "A_x": _A_in["x"],
        "A_wqkv": _A_in["wqkv"],
        "A_wo": _A_in["wo"],
        "B_x": _B_in["x"],
        "B_w1": _B_in["w1"],
        "B_w2": _B_in["w2"],
    }

def reference(A_x, A_wqkv, A_wo, B_x, B_w1, B_w2):
    def _A_ref(x, wqkv, wo):
        B, S, D = x.shape
        H = 16; Dh = D // H
        qkv = (lambda x, *d: x.permute(*d))((x @ wqkv).reshape(B, S, 3, H, Dh), 2, 0, 3, 1, 4)
        q, k, v = qkv[0], qkv[1], qkv[2]
        phi = lambda t: torch.where(t > 0, t + 1, torch.exp(t)) + 1e-6
        pq, pk = phi(q), phi(k)
        kv = torch.einsum("bhsd,bhse->bhde", pk, v)
        z = torch.einsum("bhsd->bhd", pk)
        num = torch.einsum("bhqd,bhde->bhqe", pq, kv)
        den = torch.einsum("bhqd,bhd->bhq", pq, z)[..., None] + 1e-6
        o = num / den
        return (lambda x, *d: x.permute(*d))(o, 0, 2, 1, 3).reshape(B, S, D) @ wo

    def _B_ref(x, w1, w2):
        h = torch.einsum("bsd,df->bsf", x, w1)
        h = _silu(h)
        out = torch.einsum("bsf,fd->bsd", h, w2)
        return out

    x = A_x
    xn = _layernorm(x, axis=-1)
    s = _A_ref(xn, A_wqkv, A_wo)
    g = _silu(_B_ref(xn, B_w1, B_w2))
    return x + s * g
```

```asm
; @launch grid=(256,1,1) block=(512,1,1) lds=163840
.amdgcn_target "amdgcn-amd-amdhsa--gfx950"
.text
.globl recurrent_scan__linear_attn_block__dense_activation_silu__prompt_kernel
.p2align 8
.type recurrent_scan__linear_attn_block__dense_activation_silu__prompt_kernel,@function
recurrent_scan__linear_attn_block__dense_activation_silu__prompt_kernel:
    s_cmp_ge_u32 s2, 256
    s_cbranch_scc1 L_end
    v_and_b32 v1, 63, v0
    v_lshrrev_b32 v224, 6, v0
    s_load_dwordx4 s[4:7], s[0:1], 0
    s_load_dwordx2 s[8:9], s[0:1], 16
    s_load_dwordx4 s[12:15], s[0:1], 32
    s_load_dwordx4 s[96:99], s[0:1], 48
    s_load_dwordx2 s[18:19], s[0:1], 64
    s_lshr_b32 s41, s2, 3
    s_xor_b32 s41, s41, 16
    v_readfirstlane_b32 s36, v224
    s_and_b32 s39, s2, 7
    s_lshl_b32 s39, s39, 1
    s_and_b32 s42, s41, 1
    s_add_u32 s39, s39, s42
    s_lshr_b32 s46, s41, 1
    s_and_b32 s40, s46, 7
    s_mul_i32 s42, s42, 3
    s_add_u32 s47, s46, s42
    s_mul_hi_u32 s42, s47, 0x24924925
    s_mul_i32 s42, s42, 7
    s_sub_u32 s47, s47, s42
    s_and_b32 s37, s36, 3
    s_lshr_b32 s38, s36, 2
    s_lshl_b32 s73, s39, 2
    s_add_u32 s73, s73, s37
    s_lshl_b32 s48, s73, 1
    s_add_u32 s48, s48, s38
    s_mul_i32 s48, s48, 14336
    s_add_u32 s49, s48, 896
    s_lshl_b32 s42, s47, 7
    s_add_u32 s48, s48, s42
    s_lshl_b32 s50, s37, 1
    s_add_u32 s50, s50, s38
    s_lshl_b32 s50, s50, 11
    v_lshrrev_b32 v224, 3, v1
    v_mul_u32_u24 v6, 896, v224
    v_lshrrev_b32 v224, 4, v1
    v_xor_b32 v224, v224, v1
    v_and_b32 v224, 7, v224
    v_xor_b32 v225, 4, v224
    v_lshl_add_u32 v7, v225, 4, v6
    v_lshl_add_u32 v6, v224, 4, v6
    s_mul_i32 s42, s40, 448
    s_and_b32 s43, s40, 1
    s_lshl_b32 s43, s43, 6
    s_add_u32 s42, s42, s43
    s_mul_i32 s62, s40, 112
    s_add_u32 s62, s62, 896
    s_movk_i32 s45, 2688
    s_cmp_ge_u32 s46, 8
    s_cselect_b32 s62, s42, s62
    s_cselect_b32 s45, 3584, s45
    s_cselect_b32 s85, 7, 6
    s_lshl_b32 s51, s36, 10
    s_lshl_b32 s42, s36, 3
    s_lshl_b32 s43, s47, 6
    s_add_u32 s84, s42, s43
    s_mul_i32 s66, s84, s45
    s_add_u32 s42, s84, 64
    s_cmp_ge_u32 s42, 448
    s_cselect_b32 s43, 448, 0
    s_sub_u32 s42, s42, s43
    s_mul_i32 s67, s42, s45
    v_lshrrev_b32 v224, 3, v1
    v_mul_u32_u24 v3, s45, v224
    v_lshlrev_b32 v224, 1, v224
    v_and_b32 v224, 4, v224
    v_and_b32 v225, 7, v1
    v_xor_b32 v224, v224, v225
    v_min_u32 v224, s85, v224
    v_lshl_add_u32 v3, v224, 4, v3
    s_waitcnt lgkmcnt(0)
    s_mov_b32 s20, s4
    s_mov_b32 s21, s5
    s_mov_b32 s22, 1835008
    s_mov_b32 s23, 0x20000
    s_add_u32 m0, s50, 49152
    s_nop 0
    buffer_load_dwordx4 v6, s[20:23], s48 offen lds
    s_add_u32 m0, s50, 50176
    s_add_u32 s42, s48, 7168
    buffer_load_dwordx4 v7, s[20:23], s42 offen lds
    s_cmp_eq_u32 s38, 1
    s_cbranch_scc0 L_prio
    s_setprio 1
L_prio:
    s_cmp_lt_u32 s46, 8
    s_cbranch_scc1 L_qkv
L_ffn:
    s_mov_b32 s16, 1605632
    s_add_u32 s24, s12, s62
    s_addc_u32 s25, s13, 0
    s_sub_u32 s26, s16, s62
    s_mov_b32 s27, 0x20000
    s_add_u32 m0, s51, 8192
    s_nop 0
    buffer_load_dwordx4 v3, s[24:27], s66 offen lds
    s_add_u32 m0, s50, 65536
    s_add_u32 s48, s48, 128
    s_cmp_eq_u32 s48, s49
    s_cselect_b32 s42, 896, 0
    s_sub_u32 s48, s48, s42
    buffer_load_dwordx4 v6, s[20:23], s48 offen lds
    s_add_u32 m0, s50, 66560
    s_add_u32 s42, s48, 7168
    buffer_load_dwordx4 v7, s[20:23], s42 offen lds
    s_add_u32 m0, s51, 16384
    s_nop 0
    buffer_load_dwordx4 v3, s[24:27], s67 offen lds
    s_mov_b32 s92, s98
    s_mov_b32 s93, s99
    s_mov_b32 s94, 256
    s_mov_b32 s95, 0x20000
    s_memrealtime s[56:57]
    s_cmp_eq_u32 s2, 0
    s_cselect_b32 s42, 0, 1
    s_add_u32 s42, s42, s36
    s_lshl_b32 s42, s42, 8
    v_mov_b32 v226, 0
    s_waitcnt lgkmcnt(0)
    s_or_b32 s56, s56, 1
    v_mov_b32 v224, s56
    v_mov_b32 v225, s57
    s_mov_b64 exec, 1
    buffer_store_dwordx2 v[224:225], v226, s[92:95], s42 offen sc1
    s_mov_b64 exec, -1
    s_add_u32 s68, s84, 128
    s_cmp_ge_u32 s68, 448
    s_cselect_b32 s43, 448, 0
    s_sub_u32 s68, s68, s43
    s_mul_i32 s68, s68, 3584
    s_add_u32 s69, s84, 192
    s_cmp_ge_u32 s69, 448
    s_cselect_b32 s43, 448, 0
    s_sub_u32 s69, s69, s43
    s_mul_i32 s69, s69, 3584
    s_add_u32 s70, s84, 256
    s_cmp_ge_u32 s70, 448
    s_cselect_b32 s43, 448, 0
    s_sub_u32 s70, s70, s43
    s_mul_i32 s70, s70, 3584
    s_add_u32 s71, s84, 320
    s_cmp_ge_u32 s71, 448
    s_cselect_b32 s43, 448, 0
    s_sub_u32 s71, s71, s43
    s_mul_i32 s71, s71, 3584
    s_add_u32 s72, s84, 384
    s_cmp_ge_u32 s72, 448
    s_cselect_b32 s43, 448, 0
    s_sub_u32 s72, s72, s43
    s_mul_i32 s72, s72, 3584
    s_add_u32 s63, s62, 128
    s_add_u32 s64, s62, 256
    s_mul_i32 s42, s40, 448
    s_and_b32 s43, s40, 1
    s_add_u32 s65, s42, 384
    s_mul_i32 s43, s43, 384
    s_sub_u32 s65, s65, s43
    s_and_b32 s43, s40, 1
    s_mul_i32 s42, s40, 14336
    s_mul_i32 s84, s73, 143360
    s_add_u32 s42, s42, s84
    s_add_u32 s84, s43, s38
    s_lshl_b32 s84, s84, 11
    s_add_u32 s4, s42, s84
    s_add_u32 s5, s4, 4096
    s_add_u32 s6, s4, 8192
    s_mul_i32 s84, s43, 12288
    s_add_u32 s7, s42, 12288
    s_sub_u32 s7, s7, s84
    s_lshl_b32 s84, s38, 10
    s_add_u32 s7, s7, s84
    s_lshl_b32 s84, s38, 6
    v_lshrrev_b32 v224, 5, v1
    v_mul_u32_u24 v8, 1024, v224
    v_bfe_u32 v224, v1, 2, 2
    v_lshl_add_u32 v8, v224, 7, v8
    v_lshrrev_b32 v224, 1, v224
    v_lshlrev_b32 v224, 6, v224
    v_bfe_u32 v225, v1, 4, 1
    v_lshlrev_b32 v225, 5, v225
    v_and_b32 v226, 3, v1
    v_lshl_add_u32 v225, v226, 3, v225
    v_add_u32 v225, s84, v225
    v_xor_b32 v224, v224, v225
    v_add_u32 v8, v8, v224
    s_lshl_b32 s43, s38, 1
    s_xor_b32 s43, s43, s37
    s_lshl_b32 s43, s43, 11
    v_add_u32 v8, s43, v8
    v_xor_b32 v9, 2048, v8
    v_add_u32 v9, 8192, v9
    v_xor_b32 v10, 4096, v8
    v_add_u32 v10, 8192, v10
    v_xor_b32 v11, 6144, v8
    v_add_u32 v11, 8192, v11
    v_add_u32 v8, 8192, v8
    s_mov_b32 s28, s18
    s_mov_b32 s29, s19
    s_mov_b32 s30, 14680064
    s_mov_b32 s31, 0x20000
    s_mov_b32 s44, 0x3f803f80
    s_lshl_b32 s42, s38, 1
    s_xor_b32 s42, s42, s37
    s_lshl_b32 s84, s42, 11
    s_lshl_b32 s42, s42, 5
    s_lshl_b32 s43, s37, 12
    s_add_u32 s43, s43, 49152
    v_and_b32 v224, 31, v1
    v_lshlrev_b32 v176, 7, v224
    v_lshlrev_b32 v172, 4, v224
    v_lshrrev_b32 v224, 1, v224
    v_and_b32 v224, 7, v224
    v_lshrrev_b32 v225, 5, v1
    v_xor_b32 v224, v224, v225
    v_lshl_add_u32 v176, v224, 4, v176
    v_xor_b32 v176, s42, v176
    v_add_u32 v176, s43, v176
    v_xor_b32 v177, 32, v176
    v_xor_b32 v178, 64, v176
    v_xor_b32 v179, 96, v176
    v_lshlrev_b32 v2, 4, v1
    s_lshl_b32 s42, s38, 9
    s_add_u32 s42, s42, 3072
    v_add_u32 v172, s42, v172
    s_lshl_b32 s42, s37, 2
    v_add_u32 v171, s42, v172
    v_mov_b32 v170, 0x358637bd
    v_and_b32 v224, 15, v1
    v_bfe_u32 v225, v1, 4, 1
    v_lshlrev_b32 v225, 2, v225
    v_and_b32 v224, 7, v224
    v_cmp_eq_u32 vcc, v224, v225
    v_mov_b32 v226, s44
    s_nop 0
    v_cndmask_b32 v164, 0, v226, vcc
    v_mov_b32 v165, v164
    v_mov_b32 v166, v164
    v_mov_b32 v167, v164
    v_mov_b32 v184, 0
    v_mov_b32 v185, 0
    v_mov_b32 v186, 0
    v_mov_b32 v187, 0
    s_mov_b32 s18, 122880
    s_mov_b32 s19, 65536
    s_waitcnt vmcnt(4)
    s_barrier
    ds_read_b128 v[16:19], v176 offset:0
    ds_read_b128 v[20:23], v177 offset:0
    ds_read_b64_tr_b16 a[0:1], v8 offset:0
    ds_read_b64_tr_b16 a[2:3], v8 offset:512
    ds_read_b64_tr_b16 a[4:5], v9 offset:0
    ds_read_b64_tr_b16 a[6:7], v9 offset:512
    ds_read_b64_tr_b16 a[8:9], v10 offset:0
    ds_read_b64_tr_b16 a[10:11], v10 offset:512
    ds_read_b128 v[24:27], v178 offset:0
    ds_read_b128 v[28:31], v179 offset:0
    s_add_u32 m0, s50, 81920
    s_add_u32 s48, s48, 128
    s_cmp_eq_u32 s48, s49
    s_cselect_b32 s42, 896, 0
    s_sub_u32 s48, s48, s42
    buffer_load_dwordx4 v6, s[20:23], s48 offen lds
    s_add_u32 m0, s50, 82944
    s_add_u32 s42, s48, 7168
    buffer_load_dwordx4 v7, s[20:23], s42 offen lds
    s_add_u32 m0, s51, 24576
    s_nop 0
    buffer_load_dwordx4 v3, s[24:27], s68 offen lds
    s_waitcnt lgkmcnt(6)
    v_mfma_f32_32x32x16_bf16 v[128:143], a[0:3], v[16:19], 0
    v_mfma_f32_16x16x32_bf16 v[160:163], v[164:167], a[0:3], 0
    s_waitcnt vmcnt(4)
    s_barrier
    ds_read_b128 v[32:35], v176 offset:16384
    ds_read_b128 v[36:39], v177 offset:16384
    s_lshl_b32 s76, s73, 8
    s_add_u32 s76, s76, 13107200
    s_lshl_b32 s42, s46, 1
    s_add_u32 s42, s42, s38
    s_lshl_b32 s42, s42, 3
    s_add_u32 s76, s76, s42
    s_mul_i32 s73, s73, 143360
    s_and_b32 s42, s2, 7
    s_lshl_b32 s42, s42, 2
    s_add_u32 s42, s42, s41
    s_sub_u32 s42, s42, 14
    s_and_b32 s78, s41, 1
    s_add_u32 s42, s42, s78
    s_add_u32 s42, s42, s38
    s_lshl_b32 s78, s42, 7
    s_add_u32 s78, s78, 13205504
    s_sub_u32 s43, s41, 12
    s_lshr_b32 s43, s43, 2
    s_getreg_b32 s79, hwreg(HW_REG_XCC_ID, 0, 4)
    s_cmp_lt_u32 s41, 12
    s_cselect_b32 s42, 0, 4
    s_sub_u32 s42, s41, s42
    s_lshr_b32 s82, s42, 2
    s_and_b32 s42, s42, 3
    s_and_b32 s81, s2, 7
    s_lshl_b32 s81, s81, 2
    s_add_u32 s81, s81, s42
    s_min_u32 s83, s82, 6
    s_mov_b32 s32, s14
    s_mov_b32 s33, s15
    s_mov_b32 s100, s14
    s_mov_b32 s101, s15
    s_mov_b32 s35, 0x20000
    s_mov_b32 s88, s8
    s_mov_b32 s89, s9
    s_mov_b32 s91, 0x20000
    s_cmp_eq_u32 s43, 0
    s_cselect_b32 s34, 0, 1605632
    s_cselect_b32 s90, 0, 401408
    v_lshrrev_b32 v224, 3, v1
    v_mul_u32_u24 v5, 896, v224
    v_lshlrev_b32 v224, 1, v224
    v_and_b32 v224, 4, v224
    v_and_b32 v225, 7, v1
    v_xor_b32 v224, v224, v225
    v_lshl_add_u32 v5, v224, 4, v5
    ds_read_b64_tr_b16 a[12:13], v11 offset:0
    ds_read_b64_tr_b16 a[14:15], v11 offset:512
    s_waitcnt lgkmcnt(8)
    v_mfma_f32_32x32x16_bf16 v[128:143], a[4:7], v[20:23], v[128:143]
    ds_read_b128 v[40:43], v178 offset:16384
    s_add_u32 m0, s50, 98304
    s_add_u32 s48, s48, 128
    s_cmp_eq_u32 s48, s49
    s_cselect_b32 s42, 896, 0
    s_sub_u32 s48, s48, s42
    buffer_load_dwordx4 v6, s[20:23], s48 offen lds
    ds_read_b64_tr_b16 a[16:17], v8 offset:8192
    ds_read_b64_tr_b16 a[18:19], v8 offset:8704
    s_waitcnt lgkmcnt(8)
    v_mfma_f32_32x32x16_bf16 v[128:143], a[8:11], v[24:27], v[128:143]
    ds_read_b128 v[44:47], v179 offset:16384
    s_add_u32 m0, s50, 99328
    s_add_u32 s42, s48, 7168
    buffer_load_dwordx4 v7, s[20:23], s42 offen lds
    v_dot2c_f32_bf16 v186, v16, v16
    v_dot2c_f32_bf16 v187, v17, v17
    v_dot2c_f32_bf16 v186, v18, v18
    v_dot2c_f32_bf16 v187, v19, v19
    v_dot2c_f32_bf16 v186, v20, v20
    v_dot2c_f32_bf16 v187, v21, v21
    v_dot2c_f32_bf16 v186, v22, v22
    v_dot2c_f32_bf16 v187, v23, v23
    v_mfma_f32_16x16x32_bf16 v[192:195], v[164:167], v[16:19], 0
    v_mfma_f32_16x16x32_bf16 v[192:195], v[164:167], v[20:23], v[192:195]
    ds_read_b64_tr_b16 a[0:1], v9 offset:8192
    ds_read_b64_tr_b16 a[2:3], v9 offset:8704
    s_waitcnt lgkmcnt(6)
    v_mfma_f32_32x32x16_bf16 v[128:143], a[12:15], v[28:31], v[128:143]
    s_add_u32 m0, s51, 32768
    s_nop 0
    buffer_load_dwordx4 v3, s[24:27], s69 offen lds
    ds_read_b64_tr_b16 a[4:5], v10 offset:8192
    ds_read_b64_tr_b16 a[6:7], v10 offset:8704
    s_waitcnt lgkmcnt(5)
    v_mfma_f32_32x32x16_bf16 v[128:143], a[16:19], v[32:35], v[128:143]
    v_mfma_f32_16x16x32_bf16 v[160:163], v[164:167], a[16:19], v[160:163]
    s_waitcnt vmcnt(3) lgkmcnt(4)
    s_barrier
    ds_read_b128 v[48:51], v176 offset:32768
    ds_read_b128 v[52:55], v177 offset:32768
    ds_read_b64_tr_b16 a[8:9], v11 offset:8192
    ds_read_b64_tr_b16 a[10:11], v11 offset:8704
    s_waitcnt lgkmcnt(6)
    v_mfma_f32_32x32x16_bf16 v[128:143], a[0:3], v[36:39], v[128:143]
    ds_read_b128 v[56:59], v178 offset:32768
    s_add_u32 m0, s50, 114688
    s_add_u32 s48, s48, 128
    s_cmp_eq_u32 s48, s49
    s_cselect_b32 s42, 896, 0
    s_sub_u32 s48, s48, s42
    buffer_load_dwordx4 v6, s[20:23], s48 offen lds
    ds_read_b64_tr_b16 a[12:13], v8 offset:16384
    ds_read_b64_tr_b16 a[14:15], v8 offset:16896
    s_waitcnt lgkmcnt(7)
    v_mfma_f32_32x32x16_bf16 v[128:143], a[4:7], v[40:43], v[128:143]
    ds_read_b128 v[60:63], v179 offset:32768
    s_add_u32 m0, s50, 115712
    s_add_u32 s42, s48, 7168
    buffer_load_dwordx4 v7, s[20:23], s42 offen lds
    v_dot2c_f32_bf16 v186, v32, v32
    v_dot2c_f32_bf16 v187, v33, v33
    v_dot2c_f32_bf16 v186, v34, v34
    v_dot2c_f32_bf16 v187, v35, v35
    v_dot2c_f32_bf16 v186, v36, v36
    v_dot2c_f32_bf16 v187, v37, v37
    v_dot2c_f32_bf16 v186, v38, v38
    v_dot2c_f32_bf16 v187, v39, v39
    v_mfma_f32_16x16x32_bf16 v[192:195], v[164:167], v[32:35], v[192:195]
    v_mfma_f32_16x16x32_bf16 v[192:195], v[164:167], v[36:39], v[192:195]
    ds_read_b64_tr_b16 a[16:17], v9 offset:16384
    ds_read_b64_tr_b16 a[18:19], v9 offset:16896
    s_waitcnt lgkmcnt(6)
    v_mfma_f32_32x32x16_bf16 v[128:143], a[8:11], v[44:47], v[128:143]
    s_add_u32 m0, s51, 40960
    s_nop 0
    buffer_load_dwordx4 v3, s[24:27], s70 offen lds
    ds_read_b64_tr_b16 a[0:1], v10 offset:16384
    ds_read_b64_tr_b16 a[2:3], v10 offset:16896
    s_waitcnt lgkmcnt(5)
    v_mfma_f32_32x32x16_bf16 v[128:143], a[12:15], v[48:51], v[128:143]
    v_mfma_f32_16x16x32_bf16 v[160:163], v[164:167], a[12:15], v[160:163]
    s_waitcnt vmcnt(3) lgkmcnt(4)
    s_barrier
    ds_read_b128 v[64:67], v176 offset:49152
    ds_read_b128 v[68:71], v177 offset:49152
    ds_read_b64_tr_b16 a[4:5], v11 offset:16384
    ds_read_b64_tr_b16 a[6:7], v11 offset:16896
    s_waitcnt lgkmcnt(6)
    v_mfma_f32_32x32x16_bf16 v[128:143], a[16:19], v[52:55], v[128:143]
    ds_read_b128 v[72:75], v178 offset:49152
    s_add_u32 m0, s50, 131072
    s_add_u32 s48, s48, 128
    s_cmp_eq_u32 s48, s49
    s_cselect_b32 s42, 896, 0
    s_sub_u32 s48, s48, s42
    buffer_load_dwordx4 v6, s[20:23], s48 offen lds
    v_mov_b32 v173, 0
    buffer_load_dwordx2 v[174:175], v173, s[92:95], 0 offen sc1
    ds_read_b64_tr_b16 a[8:9], v8 offset:24576
    ds_read_b64_tr_b16 a[10:11], v8 offset:25088
    s_waitcnt lgkmcnt(7)
    v_mfma_f32_32x32x16_bf16 v[128:143], a[0:3], v[56:59], v[128:143]
    ds_read_b128 v[76:79], v179 offset:49152
    s_add_u32 m0, s50, 132096
    s_add_u32 s42, s48, 7168
    buffer_load_dwordx4 v7, s[20:23], s42 offen lds
    v_dot2c_f32_bf16 v186, v48, v48
    v_dot2c_f32_bf16 v187, v49, v49
    v_dot2c_f32_bf16 v186, v50, v50
    v_dot2c_f32_bf16 v187, v51, v51
    v_dot2c_f32_bf16 v186, v52, v52
    v_dot2c_f32_bf16 v187, v53, v53
    v_dot2c_f32_bf16 v186, v54, v54
    v_dot2c_f32_bf16 v187, v55, v55
    v_mfma_f32_16x16x32_bf16 v[192:195], v[164:167], v[48:51], v[192:195]
    v_mfma_f32_16x16x32_bf16 v[192:195], v[164:167], v[52:55], v[192:195]
    ds_read_b64_tr_b16 a[12:13], v9 offset:24576
    ds_read_b64_tr_b16 a[14:15], v9 offset:25088
    s_waitcnt lgkmcnt(6)
    v_mfma_f32_32x32x16_bf16 v[128:143], a[4:7], v[60:63], v[128:143]
    s_add_u32 m0, s51, 49152
    s_nop 0
    buffer_load_dwordx4 v3, s[24:27], s71 offen lds
    ds_read_b64_tr_b16 a[16:17], v10 offset:24576
    ds_read_b64_tr_b16 a[18:19], v10 offset:25088
    s_waitcnt lgkmcnt(5)
    v_mfma_f32_32x32x16_bf16 v[128:143], a[8:11], v[64:67], v[128:143]
    v_mfma_f32_16x16x32_bf16 v[160:163], v[164:167], a[8:11], v[160:163]
    s_waitcnt vmcnt(4) lgkmcnt(4)
    s_barrier
    v_add_u32 v176, 65536, v176
    v_add_u32 v177, 65536, v177
    v_add_u32 v178, 65536, v178
    v_add_u32 v179, 65536, v179
    ds_read_b128 v[80:83], v176 offset:0
    ds_read_b128 v[84:87], v177 offset:0
    ds_read_b64_tr_b16 a[0:1], v11 offset:24576
    ds_read_b64_tr_b16 a[2:3], v11 offset:25088
    s_waitcnt lgkmcnt(6)
    v_mfma_f32_32x32x16_bf16 v[128:143], a[12:15], v[68:71], v[128:143]
    ds_read_b128 v[88:91], v178 offset:0
    s_add_u32 m0, s50, 147456
    s_add_u32 s48, s48, 128
    s_cmp_eq_u32 s48, s49
    s_cselect_b32 s42, 896, 0
    s_sub_u32 s48, s48, s42
    buffer_load_dwordx4 v6, s[20:23], s48 offen lds
    ds_read_b64_tr_b16 a[4:5], v8 offset:32768
    ds_read_b64_tr_b16 a[6:7], v8 offset:33280
    s_waitcnt lgkmcnt(7)
    v_mfma_f32_32x32x16_bf16 v[128:143], a[16:19], v[72:75], v[128:143]
    ds_read_b128 v[92:95], v179 offset:0
    s_add_u32 m0, s50, 148480
    s_add_u32 s42, s48, 7168
    buffer_load_dwordx4 v7, s[20:23], s42 offen lds
    v_dot2c_f32_bf16 v186, v64, v64
    v_dot2c_f32_bf16 v187, v65, v65
    v_dot2c_f32_bf16 v186, v66, v66
    v_dot2c_f32_bf16 v187, v67, v67
    v_dot2c_f32_bf16 v186, v68, v68
    v_dot2c_f32_bf16 v187, v69, v69
    v_dot2c_f32_bf16 v186, v70, v70
    v_dot2c_f32_bf16 v187, v71, v71
    v_mfma_f32_16x16x32_bf16 v[192:195], v[164:167], v[64:67], v[192:195]
    v_mfma_f32_16x16x32_bf16 v[192:195], v[164:167], v[68:71], v[192:195]
    ds_read_b64_tr_b16 a[8:9], v9 offset:32768
    ds_read_b64_tr_b16 a[10:11], v9 offset:33280
    s_waitcnt lgkmcnt(6)
    v_mfma_f32_32x32x16_bf16 v[128:143], a[0:3], v[76:79], v[128:143]
    s_add_u32 m0, s51, 57344
    s_nop 0
    buffer_load_dwordx4 v3, s[24:27], s72 offen lds
    ds_read_b64_tr_b16 a[12:13], v10 offset:32768
    ds_read_b64_tr_b16 a[14:15], v10 offset:33280
    s_waitcnt lgkmcnt(5)
    v_mfma_f32_32x32x16_bf16 v[128:143], a[4:7], v[80:83], v[128:143]
    v_mfma_f32_16x16x32_bf16 v[160:163], v[164:167], a[4:7], v[160:163]
    s_waitcnt vmcnt(3) lgkmcnt(4)
    s_barrier
    ds_read_b128 v[96:99], v176 offset:16384
    ds_read_b128 v[100:103], v177 offset:16384
    ds_read_b64_tr_b16 a[16:17], v11 offset:32768
    ds_read_b64_tr_b16 a[18:19], v11 offset:33280
    s_waitcnt lgkmcnt(6)
    v_mfma_f32_32x32x16_bf16 v[128:143], a[8:11], v[84:87], v[128:143]
    ds_read_b128 v[104:107], v178 offset:16384
    s_add_u32 s24, s12, s63
    s_addc_u32 s25, s13, 0
    s_sub_u32 s26, s16, s63
    s_mov_b32 s27, 0x20000
    s_add_u32 m0, s51, 65536
    s_nop 0
    buffer_load_dwordx4 v3, s[24:27], s66 offen lds
    v_readfirstlane_b32 s56, v174
    v_readfirstlane_b32 s57, v175
    s_nop 0
    s_cmp_lg_u32 s56, 0
    s_cbranch_scc1 L_tk_f_ok
    s_mov_b32 s80, 0
L_tk_f_spin:
    s_add_u32 s80, s80, 1
    s_cmp_gt_u32 s80, 1048576
    s_cbranch_scc1 L_end
    buffer_load_dwordx2 v[174:175], v173, s[92:95], 0 offen sc1
    s_waitcnt vmcnt(0)
    v_readfirstlane_b32 s56, v174
    v_readfirstlane_b32 s57, v175
    s_nop 0
    s_cmp_lg_u32 s56, 0
    s_cbranch_scc0 L_tk_f_spin
L_tk_f_ok:
    s_add_u32 s79, s79, s57
    v_mov_b32 v174, s56
    v_mov_b32 v175, s79
    s_lshl_b32 s42, s2, 7
    s_add_u32 s42, s42, 13238272
    s_cmp_eq_u32 s36, 0
    s_cselect_b32 s42, s42, 14680064
    s_mov_b64 exec, 1
    buffer_store_dwordx2 v[174:175], v173, s[28:31], s42 offen sc1
    s_mov_b64 exec, -1
    ds_read_b64_tr_b16 a[0:1], v8 offset:40960
    ds_read_b64_tr_b16 a[2:3], v8 offset:41472
    s_waitcnt lgkmcnt(7)
    v_mfma_f32_32x32x16_bf16 v[128:143], a[12:15], v[88:91], v[128:143]
    ds_read_b128 v[108:111], v179 offset:16384
    s_add_u32 m0, s51, 73728
    s_nop 0
    buffer_load_dwordx4 v3, s[24:27], s67 offen lds
    v_dot2c_f32_bf16 v186, v80, v80
    v_dot2c_f32_bf16 v187, v81, v81
    v_dot2c_f32_bf16 v186, v82, v82
    v_dot2c_f32_bf16 v187, v83, v83
    v_dot2c_f32_bf16 v186, v84, v84
    v_dot2c_f32_bf16 v187, v85, v85
    v_dot2c_f32_bf16 v186, v86, v86
    v_dot2c_f32_bf16 v187, v87, v87
    v_mfma_f32_16x16x32_bf16 v[192:195], v[164:167], v[80:83], v[192:195]
    v_mfma_f32_16x16x32_bf16 v[192:195], v[164:167], v[84:87], v[192:195]
    ds_read_b64_tr_b16 a[4:5], v9 offset:40960
    ds_read_b64_tr_b16 a[6:7], v9 offset:41472
    s_waitcnt lgkmcnt(6)
    v_mfma_f32_32x32x16_bf16 v[128:143], a[16:19], v[92:95], v[128:143]
    s_add_u32 m0, s51, 81920
    s_nop 0
    buffer_load_dwordx4 v3, s[24:27], s68 offen lds
    ds_read_b64_tr_b16 a[8:9], v10 offset:40960
    ds_read_b64_tr_b16 a[10:11], v10 offset:41472
    s_waitcnt lgkmcnt(5)
    v_mfma_f32_32x32x16_bf16 v[128:143], a[0:3], v[96:99], v[128:143]
    v_mfma_f32_16x16x32_bf16 v[160:163], v[164:167], a[0:3], v[160:163]
    s_waitcnt vmcnt(4) lgkmcnt(4)
    s_barrier
    ds_read_b128 v[112:115], v176 offset:32768
    ds_read_b128 v[116:119], v177 offset:32768
    ds_read_b64_tr_b16 a[12:13], v11 offset:40960
    ds_read_b64_tr_b16 a[14:15], v11 offset:41472
    s_waitcnt lgkmcnt(6)
    v_mfma_f32_32x32x16_bf16 v[128:143], a[4:7], v[100:103], v[128:143]
    ds_read_b128 v[120:123], v178 offset:32768
    s_add_u32 m0, s51, 90112
    s_nop 0
    buffer_load_dwordx4 v3, s[24:27], s69 offen lds
    ds_read_b64_tr_b16 a[16:17], v8 offset:49152
    ds_read_b64_tr_b16 a[18:19], v8 offset:49664
    s_waitcnt lgkmcnt(7)
    v_mfma_f32_32x32x16_bf16 v[128:143], a[8:11], v[104:107], v[128:143]
    ds_read_b128 v[124:127], v179 offset:32768
    s_add_u32 m0, s51, 98304
    s_nop 0
    buffer_load_dwordx4 v3, s[24:27], s70 offen lds
    v_dot2c_f32_bf16 v186, v96, v96
    v_dot2c_f32_bf16 v187, v97, v97
    v_dot2c_f32_bf16 v186, v98, v98
    v_dot2c_f32_bf16 v187, v99, v99
    v_dot2c_f32_bf16 v186, v100, v100
    v_dot2c_f32_bf16 v187, v101, v101
    v_dot2c_f32_bf16 v186, v102, v102
    v_dot2c_f32_bf16 v187, v103, v103
    v_mfma_f32_16x16x32_bf16 v[192:195], v[164:167], v[96:99], v[192:195]
    v_mfma_f32_16x16x32_bf16 v[192:195], v[164:167], v[100:103], v[192:195]
    ds_read_b64_tr_b16 a[0:1], v9 offset:49152
    ds_read_b64_tr_b16 a[2:3], v9 offset:49664
    s_waitcnt lgkmcnt(6)
    v_mfma_f32_32x32x16_bf16 v[128:143], a[12:15], v[108:111], v[128:143]
    s_add_u32 m0, s51, 106496
    s_nop 0
    buffer_load_dwordx4 v3, s[24:27], s71 offen lds
    ds_read_b64_tr_b16 a[4:5], v10 offset:49152
    ds_read_b64_tr_b16 a[6:7], v10 offset:49664
    s_waitcnt lgkmcnt(5)
    v_mfma_f32_32x32x16_bf16 v[128:143], a[16:19], v[112:115], v[128:143]
    v_mfma_f32_16x16x32_bf16 v[160:163], v[164:167], a[16:19], v[160:163]
    s_waitcnt vmcnt(4)
    s_barrier
    ds_read_b64_tr_b16 a[8:9], v11 offset:49152
    ds_read_b64_tr_b16 a[10:11], v11 offset:49664
    s_waitcnt lgkmcnt(4)
    v_mfma_f32_32x32x16_bf16 v[128:143], a[0:3], v[116:119], v[128:143]
    ds_read_b64_tr_b16 a[12:13], v8 offset:57344
    ds_read_b64_tr_b16 a[14:15], v8 offset:57856
    s_waitcnt lgkmcnt(4)
    v_mfma_f32_32x32x16_bf16 v[128:143], a[4:7], v[120:123], v[128:143]
    v_dot2c_f32_bf16 v186, v112, v112
    v_dot2c_f32_bf16 v187, v113, v113
    v_dot2c_f32_bf16 v186, v114, v114
    v_dot2c_f32_bf16 v187, v115, v115
    v_dot2c_f32_bf16 v186, v116, v116
    v_dot2c_f32_bf16 v187, v117, v117
    v_dot2c_f32_bf16 v186, v118, v118
    v_dot2c_f32_bf16 v187, v119, v119
    v_mfma_f32_16x16x32_bf16 v[192:195], v[164:167], v[112:115], v[192:195]
    v_mfma_f32_16x16x32_bf16 v[192:195], v[164:167], v[116:119], v[192:195]
    ds_read_b64_tr_b16 a[16:17], v9 offset:57344
    ds_read_b64_tr_b16 a[18:19], v9 offset:57856
    s_waitcnt lgkmcnt(4)
    v_mfma_f32_32x32x16_bf16 v[128:143], a[8:11], v[124:127], v[128:143]
    ds_read_b64_tr_b16 a[0:1], v10 offset:57344
    ds_read_b64_tr_b16 a[2:3], v10 offset:57856
    s_waitcnt lgkmcnt(4)
    v_mfma_f32_32x32x16_bf16 v[144:159], a[12:15], v[16:19], 0
    s_add_u32 m0, s51, 114688
    s_nop 0
    buffer_load_dwordx4 v3, s[24:27], s72 offen lds
    ds_read_b64_tr_b16 a[4:5], v11 offset:57344
    ds_read_b64_tr_b16 a[6:7], v11 offset:57856
    v_add_f32 v186, v186, v187
    s_lshl_b32 s84, s37, 1
    v_mov_b32 v187, v186
    s_add_u32 s84, s84, s38
    s_lshl_b32 s84, s84, 8
    s_waitcnt lgkmcnt(4)
    v_mfma_f32_32x32x16_bf16 v[144:159], a[16:19], v[20:23], v[144:159]
    s_add_u32 s24, s12, s64
    s_addc_u32 s25, s13, 0
    s_sub_u32 s26, s16, s64
    s_mov_b32 s27, 0x20000
    s_add_u32 m0, s51, 122880
    s_nop 0
    buffer_load_dwordx4 v3, s[24:27], s66 offen lds
    v_lshlrev_b32 v196, 7, v1
    s_mov_b64 exec, 65535
    buffer_load_dword v197, v196, s[28:31], s4 offen
    s_mov_b64 exec, -1
    v_add_u32 v8, 65536, v8
    ds_read_b64_tr_b16 a[8:9], v8 offset:0
    ds_read_b64_tr_b16 a[10:11], v8 offset:512
    v_permlane32_swap_b32 v186, v187
    v_mov_b32 v184, v192
    v_add_f32 v185, v186, v187
    v_and_b32 v224, 31, v1
    s_waitcnt lgkmcnt(4)
    v_mfma_f32_32x32x16_bf16 v[144:159], a[0:3], v[24:27], v[144:159]
    s_add_u32 m0, s51, 131072
    s_nop 0
    buffer_load_dwordx4 v3, s[24:27], s67 offen lds
    v_add_u32 v9, 65536, v9
    ds_read_b64_tr_b16 a[12:13], v9 offset:0
    ds_read_b64_tr_b16 a[14:15], v9 offset:512
    v_lshl_add_u32 v224, v224, 3, s84
    ds_write_b64 v224, v[184:185] offset:0
    v_xor_b32 v224, 256, v224
    ds_write_b32 v171, v160 offset:0
    s_waitcnt lgkmcnt(6)
    v_mfma_f32_32x32x16_bf16 v[144:159], a[4:7], v[28:31], v[144:159]
    s_waitcnt vmcnt(6) lgkmcnt(0)
    s_barrier
    v_add_u32 v10, 65536, v10
    ds_read_b64_tr_b16 a[16:17], v10 offset:0
    ds_read_b64_tr_b16 a[18:19], v10 offset:512
    ds_read_b64 v[186:187], v224 offset:0
    s_mov_b32 s45, 3216550459
    s_mov_b32 s60, -1
    s_mov_b32 s61, 0
    s_waitcnt lgkmcnt(0)
    v_add_f32 v184, v184, v186
    v_add_f32 v185, v185, v187
    v_mul_f32 v184, 0xbb124925, v184
    v_mfma_f32_32x32x16_bf16 v[144:159], a[8:11], v[32:35], v[144:159]
    v_mfma_f32_16x16x32_bf16 v[160:163], v[164:167], a[8:11], 0
    s_add_u32 m0, s51, 139264
    s_nop 0
    buffer_load_dwordx4 v3, s[24:27], s68 offen lds
    v_add_u32 v11, 65536, v11
    ds_read_b64_tr_b16 a[0:1], v11 offset:0
    ds_read_b64_tr_b16 a[2:3], v11 offset:512
    v_mul_f32 v185, 0x3b124925, v185
    v_fma_f32 v185, -v184, v184, v185
    v_max_f32 v185, 0, v185
    v_add_f32 v185, 0x3727c5ac, v185
    v_rsq_f32 v185, v185
    v_mfma_f32_32x32x16_bf16 v[144:159], a[12:15], v[36:39], v[144:159]
    ds_read_b64_tr_b16 a[4:5], v8 offset:8192
    ds_read_b64_tr_b16 a[6:7], v8 offset:8704
    v_cvt_pk_bf16_f32 v186, v184, v184
    v_mul_f32 v13, s45, v185
    v_lshlrev_b32 v187, 16, v186
    v_sub_f32 v187, v184, v187
    v_cvt_pk_bf16_f32 v187, v187, 0
    v_cndmask_b32 v14, 0, v186, s[60:61]
    v_mfma_f32_32x32x16_bf16 v[144:159], a[16:19], v[40:43], v[144:159]
    s_add_u32 m0, s51, 147456
    s_nop 0
    buffer_load_dwordx4 v3, s[24:27], s69 offen lds
    ds_read_b64_tr_b16 a[8:9], v9 offset:8192
    ds_read_b64_tr_b16 a[10:11], v9 offset:8704
    v_cndmask_b32 v15, 0, v187, s[60:61]
    ds_read_b128 v[224:227], v172 offset:0
    s_waitcnt lgkmcnt(0)
    v_add_f32 v224, v224, v225
    v_add_f32 v226, v226, v227
    v_add_f32 v224, v224, v226
    v_cvt_pk_bf16_f32 v225, v224, v224
    v_mfma_f32_32x32x16_bf16 v[144:159], a[0:3], v[44:47], v[144:159]
    ds_read_b64_tr_b16 a[12:13], v10 offset:8192
    ds_read_b64_tr_b16 a[14:15], v10 offset:8704
    v_lshlrev_b32 v225, 16, v225
    v_sub_f32 v225, v224, v225
    v_cvt_pk_bf16_f32 v168, v224, v225
    v_and_b32 v169, 0xffff, v168
    s_nop 1
    v_mfma_f32_32x32x8bf16_1k v[128:143], v[168:169], v[14:15], v[128:143]
    v_mfma_f32_32x32x16_bf16 v[144:159], a[4:7], v[48:51], v[144:159]
    v_mfma_f32_16x16x32_bf16 v[160:163], v[164:167], a[4:7], v[160:163]
    s_add_u32 m0, s51, 155648
    s_nop 0
    buffer_load_dwordx4 v3, s[24:27], s70 offen lds
    ds_read_b64_tr_b16 a[16:17], v11 offset:8192
    ds_read_b64_tr_b16 a[18:19], v11 offset:8704
    v_mfma_f32_32x32x16_bf16 v[144:159], a[8:11], v[52:55], v[144:159]
    ds_read_b64_tr_b16 a[0:1], v8 offset:16384
    ds_read_b64_tr_b16 a[2:3], v8 offset:16896
    s_waitcnt lgkmcnt(4)
    v_mfma_f32_32x32x16_bf16 v[144:159], a[12:15], v[56:59], v[144:159]
    s_add_u32 m0, s51, 8192
    s_nop 0
    buffer_load_dwordx4 v3, s[24:27], s71 offen lds
    ds_read_b64_tr_b16 a[4:5], v9 offset:16384
    ds_read_b64_tr_b16 a[6:7], v9 offset:16896
    v_mul_f32 v128, v128, v13
    v_mul_f32 v129, v129, v13
    v_mul_f32 v130, v130, v13
    v_mul_f32 v131, v131, v13
    v_mul_f32 v132, v132, v13
    v_mul_f32 v133, v133, v13
    v_mul_f32 v134, v134, v13
    s_waitcnt lgkmcnt(4)
    v_mfma_f32_32x32x16_bf16 v[144:159], a[16:19], v[60:63], v[144:159]
    ds_read_b64_tr_b16 a[8:9], v10 offset:16384
    ds_read_b64_tr_b16 a[10:11], v10 offset:16896
    v_mul_f32 v135, v135, v13
    v_exp_f32 v176, v128
    v_exp_f32 v177, v129
    v_exp_f32 v178, v130
    s_waitcnt lgkmcnt(4)
    v_mfma_f32_32x32x16_bf16 v[144:159], a[0:3], v[64:67], v[144:159]
    v_mfma_f32_16x16x32_bf16 v[160:163], v[164:167], a[0:3], v[160:163]
    s_waitcnt vmcnt(7)
    s_barrier
    s_add_u32 m0, s51, 16384
    s_nop 0
    buffer_load_dwordx4 v3, s[24:27], s72 offen lds
    ds_read_b64_tr_b16 a[12:13], v11 offset:16384
    ds_read_b64_tr_b16 a[14:15], v11 offset:16896
    v_exp_f32 v179, v131
    v_exp_f32 v180, v132
    v_exp_f32 v181, v133
    s_waitcnt lgkmcnt(4)
    v_mfma_f32_32x32x16_bf16 v[144:159], a[4:7], v[68:71], v[144:159]
    v_add_u32 v12, 4294959104, v8
    ds_read_b64_tr_b16 a[20:21], v12
    ds_read_b64_tr_b16 a[22:23], v12 offset:512
    ds_read_b64_tr_b16 a[16:17], v8 offset:24576
    ds_read_b64_tr_b16 a[18:19], v8 offset:25088
    v_exp_f32 v182, v134
    v_exp_f32 v183, v135
    v_add_f32 v176, 1.0, v176
    v_add_f32 v177, 1.0, v177
    v_add_f32 v178, 1.0, v178
    s_waitcnt lgkmcnt(6)
    v_mfma_f32_32x32x16_bf16 v[144:159], a[8:11], v[72:75], v[144:159]
    v_add_u32 v12, 24576, v8
    ds_read_b64_tr_b16 a[24:25], v12
    ds_read_b64_tr_b16 a[26:27], v12 offset:512
    ds_read_b64_tr_b16 a[0:1], v9 offset:24576
    ds_read_b64_tr_b16 a[2:3], v9 offset:25088
    v_add_f32 v179, 1.0, v179
    v_add_f32 v180, 1.0, v180
    v_add_f32 v181, 1.0, v181
    v_add_f32 v182, 1.0, v182
    v_add_f32 v183, 1.0, v183
    v_rcp_f32 v176, v176
    s_waitcnt lgkmcnt(8)
    v_mfma_f32_32x32x16_bf16 v[144:159], a[12:15], v[76:79], v[144:159]
    s_waitcnt lgkmcnt(6)
    v_mfma_f32_16x16x32_bf16 v[160:163], v[164:167], a[20:23], v[160:163]
    v_add_u32 v12, 32768, v8
    ds_read_b64_tr_b16 a[20:21], v12
    ds_read_b64_tr_b16 a[22:23], v12 offset:512
    ds_read_b64_tr_b16 a[4:5], v10 offset:24576
    ds_read_b64_tr_b16 a[6:7], v10 offset:25088
    v_rcp_f32 v177, v177
    v_rcp_f32 v178, v178
    v_rcp_f32 v179, v179
    s_waitcnt lgkmcnt(8)
    v_mfma_f32_32x32x16_bf16 v[144:159], a[16:19], v[80:83], v[144:159]
    s_lshl_b32 s10, s37, 3
    s_lshr_b32 s10, 117835012, s10
    s_and_b32 s10, s10, 31
    s_lshl_b32 s10, s10, 13
    s_lshl_b32 s17, s38, 12
    s_add_u32 s10, s10, s17
    s_mul_i32 s86, s37, 401408
    s_lshl_b32 s17, s82, 7
    s_add_u32 s86, s86, s17
    s_mul_i32 s17, s38, 28672
    s_add_u32 s86, s86, s17
    s_add_u32 s87, s83, 0
    s_cmp_ge_u32 s87, 7
    s_cselect_b32 s17, 7, 0
    s_sub_u32 s87, s87, s17
    s_mul_i32 s87, s87, 57344
    s_add_u32 s86, s86, s87
    s_add_u32 m0, s10, 0
    s_nop 0
    buffer_load_dwordx4 v5, s[32:35], s86 offen lds
    v_lshrrev_b32 v174, 5, v1
    v_lshlrev_b32 v7, 9, v174
    v_bfe_u32 v174, v1, 2, 2
    v_lshl_add_u32 v7, v174, 6, v7
    v_bfe_u32 v174, v1, 4, 1
    v_xor_b32 v174, s38, v174
    v_lshl_add_u32 v7, v174, 5, v7
    v_and_b32 v174, 3, v1
    v_lshl_add_u32 v7, v174, 3, v7
    s_lshl_b32 s42, s38, 1
    s_xor_b32 s42, s42, s37
    s_lshl_b32 s42, s42, 10
    v_add_u32 v7, s42, v7
    s_waitcnt lgkmcnt(6)
    v_mfma_f32_16x16x32_bf16 v[160:163], v[164:167], a[24:27], v[160:163]
    v_add_u32 v12, 40960, v8
    ds_read_b64_tr_b16 a[24:25], v12
    ds_read_b64_tr_b16 a[26:27], v12 offset:512
    ds_read_b64_tr_b16 a[8:9], v11 offset:24576
    ds_read_b64_tr_b16 a[10:11], v11 offset:25088
    v_rcp_f32 v180, v180
    v_rcp_f32 v181, v181
    v_rcp_f32 v182, v182
    v_rcp_f32 v183, v183
    s_waitcnt lgkmcnt(8)
    v_mfma_f32_32x32x16_bf16 v[144:159], a[0:3], v[84:87], v[144:159]
    s_waitcnt lgkmcnt(6)
    v_mfma_f32_16x16x32_bf16 v[160:163], v[164:167], a[20:23], v[160:163]
    ds_read_b64_tr_b16 a[12:13], v8 offset:32768
    ds_read_b64_tr_b16 a[14:15], v8 offset:33280
    v_mul_f32 v176, v128, v176
    v_mul_f32 v177, v129, v177
    v_mul_f32 v178, v130, v178
    v_mul_f32 v179, v131, v179
    v_mul_f32 v180, v132, v180
    v_mul_f32 v181, v133, v181
    s_waitcnt lgkmcnt(6)
    v_mfma_f32_32x32x16_bf16 v[144:159], a[4:7], v[88:91], v[144:159]
    s_add_u32 m0, s10, 1024
    s_add_u32 s86, s86, 7168
    buffer_load_dwordx4 v5, s[32:35], s86 offen lds
    s_waitcnt lgkmcnt(4)
    v_mfma_f32_16x16x32_bf16 v[160:163], v[164:167], a[24:27], v[160:163]
    ds_read_b64_tr_b16 a[16:17], v9 offset:32768
    ds_read_b64_tr_b16 a[18:19], v9 offset:33280
    v_mul_f32 v182, v134, v182
    v_mul_f32 v183, v135, v183
    v_cvt_pk_bf16_f32 v184, v176, v177
    v_cvt_pk_bf16_f32 v185, v178, v179
    v_cvt_pk_bf16_f32 v186, v180, v181
    v_cvt_pk_bf16_f32 v187, v182, v183
    buffer_store_dwordx4 v[184:187], v2, s[28:31], s4 offen offset:0
    s_waitcnt lgkmcnt(4)
    v_mfma_f32_32x32x16_bf16 v[144:159], a[8:11], v[92:95], v[144:159]
    ds_read_b64_tr_b16 a[0:1], v10 offset:32768
    ds_read_b64_tr_b16 a[2:3], v10 offset:33280
    v_mul_f32 v136, v136, v13
    v_mul_f32 v137, v137, v13
    v_mul_f32 v138, v138, v13
    v_mul_f32 v139, v139, v13
    v_mul_f32 v140, v140, v13
    v_mul_f32 v141, v141, v13
    v_mul_f32 v142, v142, v13
    s_waitcnt lgkmcnt(4)
    v_mfma_f32_32x32x16_bf16 v[144:159], a[12:15], v[96:99], v[144:159]
    s_add_u32 m0, s10, 2048
    s_add_u32 s86, s86, 7168
    buffer_load_dwordx4 v5, s[32:35], s86 offen lds
    ds_read_b64_tr_b16 a[4:5], v11 offset:32768
    ds_read_b64_tr_b16 a[6:7], v11 offset:33280
    v_mul_f32 v143, v143, v13
    v_exp_f32 v176, v136
    v_exp_f32 v177, v137
    v_exp_f32 v178, v138
    s_waitcnt lgkmcnt(4)
    v_mfma_f32_32x32x16_bf16 v[144:159], a[16:19], v[100:103], v[144:159]
    ds_write_b32 v171, v160 offset:1024
    ds_read_b64_tr_b16 a[8:9], v8 offset:40960
    ds_read_b64_tr_b16 a[10:11], v8 offset:41472
    v_exp_f32 v179, v139
    v_exp_f32 v180, v140
    v_exp_f32 v181, v141
    s_waitcnt lgkmcnt(5)
    v_mfma_f32_32x32x16_bf16 v[144:159], a[0:3], v[104:107], v[144:159]
    s_add_u32 m0, s10, 3072
    s_add_u32 s86, s86, 7168
    buffer_load_dwordx4 v5, s[32:35], s86 offen lds
    v_lshlrev_b32 v196, 7, v1
    s_mov_b64 exec, 65535
    buffer_load_dword v198, v196, s[28:31], s5 offen
    s_mov_b64 exec, -1
    ds_read_b64_tr_b16 a[12:13], v9 offset:40960
    ds_read_b64_tr_b16 a[14:15], v9 offset:41472
    v_exp_f32 v182, v142
    v_exp_f32 v183, v143
    v_add_f32 v176, 1.0, v176
    v_add_f32 v177, 1.0, v177
    v_add_f32 v178, 1.0, v178
    s_waitcnt lgkmcnt(5)
    v_mfma_f32_32x32x16_bf16 v[144:159], a[4:7], v[108:111], v[144:159]
    ds_read_b64_tr_b16 a[16:17], v10 offset:40960
    ds_read_b64_tr_b16 a[18:19], v10 offset:41472
    v_add_f32 v179, 1.0, v179
    v_add_f32 v180, 1.0, v180
    v_add_f32 v181, 1.0, v181
    v_add_f32 v182, 1.0, v182
    v_add_f32 v183, 1.0, v183
    v_rcp_f32 v176, v176
    s_waitcnt lgkmcnt(4)
    v_mfma_f32_32x32x16_bf16 v[144:159], a[8:11], v[112:115], v[144:159]
    s_waitcnt vmcnt(9)
    s_barrier
    ds_read_b128 v[224:227], v172 offset:1024
    ds_read_b64_tr_b16 a[0:1], v11 offset:40960
    ds_read_b64_tr_b16 a[2:3], v11 offset:41472
    v_rcp_f32 v177, v177
    v_rcp_f32 v178, v178
    v_rcp_f32 v179, v179
    s_waitcnt lgkmcnt(5)
    v_mfma_f32_32x32x16_bf16 v[144:159], a[12:15], v[116:119], v[144:159]
    ds_read_b64_tr_b16 a[4:5], v8 offset:49152
    ds_read_b64_tr_b16 a[6:7], v8 offset:49664
    v_rcp_f32 v180, v180
    v_rcp_f32 v181, v181
    v_rcp_f32 v182, v182
    v_rcp_f32 v183, v183
    s_waitcnt lgkmcnt(5)
    v_mfma_f32_32x32x16_bf16 v[144:159], a[16:19], v[120:123], v[144:159]
    s_add_u32 s24, s12, s65
    s_addc_u32 s25, s13, 0
    s_sub_u32 s26, s16, s65
    s_mov_b32 s27, 0x20000
    s_lshl_b32 s48, s37, 1
    s_sub_u32 s48, s48, s36
    s_mul_i32 s48, s48, 28672
    s_lshl_b32 s50, s38, 2
    s_add_u32 s50, s50, s37
    s_lshl_b32 s50, s50, 10
    v_lshrrev_b32 v4, 2, v1
    v_mul_u32_u24 v4, 3584, v4
    v_and_b32 v12, 3, v1
    v_lshl_add_u32 v4, v12, 4, v4
    s_add_u32 m0, s50, 65536
    s_add_u32 s42, s66, s48
    s_add_u32 s43, s67, s48
    s_cmp_eq_u32 s38, 0
    s_cselect_b32 s42, s42, s43
    buffer_load_dwordx4 v4, s[24:27], s42 offen lds
    s_waitcnt lgkmcnt(4)
    v_add_f32 v224, v224, v225
    v_add_f32 v226, v226, v227
    v_add_f32 v224, v224, v226
    v_cvt_pk_bf16_f32 v225, v224, v224
    ds_read_b64_tr_b16 a[8:9], v9 offset:49152
    ds_read_b64_tr_b16 a[10:11], v9 offset:49664
    v_mul_f32 v176, v136, v176
    v_mul_f32 v177, v137, v177
    v_mul_f32 v178, v138, v178
    v_mul_f32 v179, v139, v179
    v_mul_f32 v180, v140, v180
    v_mul_f32 v181, v141, v181
    s_waitcnt lgkmcnt(4)
    v_mfma_f32_32x32x16_bf16 v[144:159], a[0:3], v[124:127], v[144:159]
    v_lshlrev_b32 v225, 16, v225
    v_sub_f32 v225, v224, v225
    v_cvt_pk_bf16_f32 v168, v224, v225
    v_and_b32 v169, 0xffff, v168
    ds_read_b64_tr_b16 a[12:13], v10 offset:49152
    ds_read_b64_tr_b16 a[14:15], v10 offset:49664
    v_mul_f32 v182, v142, v182
    v_mul_f32 v183, v143, v183
    v_cvt_pk_bf16_f32 v188, v176, v177
    v_cvt_pk_bf16_f32 v189, v178, v179
    v_cvt_pk_bf16_f32 v190, v180, v181
    v_cvt_pk_bf16_f32 v191, v182, v183
    buffer_store_dwordx4 v[188:191], v2, s[28:31], s4 offen offset:1024
    v_mfma_f32_32x32x8bf16_1k v[144:159], v[168:169], v[14:15], v[144:159]
    s_waitcnt lgkmcnt(4)
    v_mfma_f32_32x32x16_bf16 v[128:143], a[4:7], v[16:19], 0
    v_mfma_f32_16x16x32_bf16 v[160:163], v[164:167], a[4:7], 0
    s_add_u32 m0, s50, 73728
    s_add_u32 s42, s68, s48
    s_add_u32 s43, s69, s48
    s_cmp_eq_u32 s38, 0
    s_cselect_b32 s42, s42, s43
    buffer_load_dwordx4 v4, s[24:27], s42 offen lds
    ds_read_b64_tr_b16 a[16:17], v11 offset:49152
    ds_read_b64_tr_b16 a[18:19], v11 offset:49664
    s_waitcnt lgkmcnt(4)
    v_mfma_f32_32x32x16_bf16 v[128:143], a[8:11], v[20:23], v[128:143]
    ds_read_b64_tr_b16 a[0:1], v8 offset:57344
    ds_read_b64_tr_b16 a[2:3], v8 offset:57856
    s_waitcnt lgkmcnt(4)
    v_mfma_f32_32x32x16_bf16 v[128:143], a[12:15], v[24:27], v[128:143]
    ds_read_b64_tr_b16 a[4:5], v9 offset:57344
    ds_read_b64_tr_b16 a[6:7], v9 offset:57856
    v_mul_f32 v144, v144, v13
    v_mul_f32 v145, v145, v13
    v_mul_f32 v146, v146, v13
    v_mul_f32 v147, v147, v13
    v_mul_f32 v148, v148, v13
    s_waitcnt lgkmcnt(4)
    v_mfma_f32_32x32x16_bf16 v[128:143], a[16:19], v[28:31], v[128:143]
    s_add_u32 m0, s50, 81920
    s_add_u32 s42, s70, s48
    s_add_u32 s43, s71, s48
    s_cmp_eq_u32 s38, 0
    s_cselect_b32 s42, s42, s43
    buffer_load_dwordx4 v4, s[24:27], s42 offen lds
    ds_read_b64_tr_b16 a[8:9], v10 offset:57344
    ds_read_b64_tr_b16 a[10:11], v10 offset:57856
    v_mul_f32 v149, v149, v13
    v_mul_f32 v150, v150, v13
    v_mul_f32 v151, v151, v13
    v_exp_f32 v176, v144
    s_waitcnt lgkmcnt(4)
    v_mfma_f32_32x32x16_bf16 v[128:143], a[0:3], v[32:35], v[128:143]
    v_mfma_f32_16x16x32_bf16 v[160:163], v[164:167], a[0:3], v[160:163]
    ds_read_b64_tr_b16 a[12:13], v11 offset:57344
    ds_read_b64_tr_b16 a[14:15], v11 offset:57856
    v_exp_f32 v177, v145
    v_exp_f32 v178, v146
    s_waitcnt lgkmcnt(4)
    v_mfma_f32_32x32x16_bf16 v[128:143], a[4:7], v[36:39], v[128:143]
    v_add_u32 v8, 65536, v8
    ds_read_b64_tr_b16 a[16:17], v8 offset:0
    ds_read_b64_tr_b16 a[18:19], v8 offset:512
    v_exp_f32 v179, v147
    v_exp_f32 v180, v148
    v_exp_f32 v181, v149
    s_waitcnt lgkmcnt(4)
    v_mfma_f32_32x32x16_bf16 v[128:143], a[8:11], v[40:43], v[128:143]
    s_add_u32 m0, s50, 90112
    s_add_u32 s42, s72, s48
    s_mov_b32 s43, 1605632
    s_cmp_eq_u32 s38, 0
    s_cselect_b32 s42, s42, s43
    buffer_load_dwordx4 v4, s[24:27], s42 offen lds
    v_add_u32 v9, 65536, v9
    ds_read_b64_tr_b16 a[0:1], v9 offset:0
    ds_read_b64_tr_b16 a[2:3], v9 offset:512
    v_exp_f32 v182, v150
    v_exp_f32 v183, v151
    s_waitcnt lgkmcnt(4)
    v_mfma_f32_32x32x16_bf16 v[128:143], a[12:15], v[44:47], v[128:143]
    v_add_u32 v10, 65536, v10
    ds_read_b64_tr_b16 a[4:5], v10 offset:0
    ds_read_b64_tr_b16 a[6:7], v10 offset:512
    v_add_f32 v176, 1.0, v176
    v_add_f32 v177, 1.0, v177
    v_add_f32 v178, 1.0, v178
    v_add_f32 v179, 1.0, v179
    v_add_f32 v180, 1.0, v180
    s_waitcnt lgkmcnt(4)
    v_mfma_f32_32x32x16_bf16 v[128:143], a[16:19], v[48:51], v[128:143]
    v_mfma_f32_16x16x32_bf16 v[160:163], v[164:167], a[16:19], v[160:163]
    v_add_u32 v11, 65536, v11
    ds_read_b64_tr_b16 a[8:9], v11 offset:0
    ds_read_b64_tr_b16 a[10:11], v11 offset:512
    v_add_f32 v181, 1.0, v181
    v_add_f32 v182, 1.0, v182
    v_add_f32 v183, 1.0, v183
    v_rcp_f32 v176, v176
    s_waitcnt lgkmcnt(4)
    v_mfma_f32_32x32x16_bf16 v[128:143], a[0:3], v[52:55], v[128:143]
    ds_read_b64_tr_b16 a[12:13], v8 offset:8192
    ds_read_b64_tr_b16 a[14:15], v8 offset:8704
    v_rcp_f32 v177, v177
    v_rcp_f32 v178, v178
    v_rcp_f32 v179, v179
    s_waitcnt lgkmcnt(4)
    v_mfma_f32_32x32x16_bf16 v[128:143], a[4:7], v[56:59], v[128:143]
    s_waitcnt vmcnt(11)
    s_barrier
    v_lshlrev_b32 v196, 7, v1
    s_mov_b64 exec, 65535
    buffer_load_dword v199, v196, s[28:31], s6 offen
    s_mov_b64 exec, -1
    ds_read_b64_tr_b16 a[16:17], v9 offset:8192
    ds_read_b64_tr_b16 a[18:19], v9 offset:8704
    v_rcp_f32 v180, v180
    v_rcp_f32 v181, v181
    s_waitcnt lgkmcnt(4)
    v_mfma_f32_32x32x16_bf16 v[128:143], a[8:11], v[60:63], v[128:143]
    s_lshl_b32 s10, s37, 3
    s_lshr_b32 s10, 235736067, s10
    s_and_b32 s10, s10, 31
    s_lshl_b32 s10, s10, 13
    s_lshl_b32 s17, s38, 12
    s_add_u32 s10, s10, s17
    s_mul_i32 s86, s37, 401408
    s_lshl_b32 s17, s82, 7
    s_add_u32 s86, s86, s17
    s_mul_i32 s17, s38, 28672
    s_add_u32 s86, s86, s17
    s_add_u32 s87, s83, 1
    s_cmp_ge_u32 s87, 7
    s_cselect_b32 s17, 7, 0
    s_sub_u32 s87, s87, s17
    s_mul_i32 s87, s87, 57344
    s_add_u32 s86, s86, s87
    s_add_u32 m0, s10, 0
    s_nop 0
    buffer_load_dwordx4 v5, s[32:35], s86 offen lds
    ds_read_b64_tr_b16 a[0:1], v10 offset:8192
    ds_read_b64_tr_b16 a[2:3], v10 offset:8704
    v_rcp_f32 v182, v182
    v_rcp_f32 v183, v183
    v_mul_f32 v176, v144, v176
    s_waitcnt lgkmcnt(4)
    v_mfma_f32_32x32x16_bf16 v[128:143], a[12:15], v[64:67], v[128:143]
    v_mfma_f32_16x16x32_bf16 v[160:163], v[164:167], a[12:15], v[160:163]
    ds_read_b64_tr_b16 a[4:5], v11 offset:8192
    ds_read_b64_tr_b16 a[6:7], v11 offset:8704
    v_mul_f32 v177, v145, v177
    v_mul_f32 v178, v146, v178
    v_mul_f32 v179, v147, v179
    v_mul_f32 v180, v148, v180
    v_mul_f32 v181, v149, v181
    s_waitcnt lgkmcnt(4)
    v_mfma_f32_32x32x16_bf16 v[128:143], a[16:19], v[68:71], v[128:143]
    v_add_u32 v12, 16384, v8
    ds_read_b64_tr_b16 a[20:21], v12
    ds_read_b64_tr_b16 a[22:23], v12 offset:512
    ds_read_b64_tr_b16 a[8:9], v8 offset:16384
    ds_read_b64_tr_b16 a[10:11], v8 offset:16896
    v_mul_f32 v182, v150, v182
    v_mul_f32 v183, v151, v183
    v_cvt_pk_bf16_f32 v184, v176, v177
    v_cvt_pk_bf16_f32 v185, v178, v179
    v_cvt_pk_bf16_f32 v186, v180, v181
    s_waitcnt lgkmcnt(6)
    v_mfma_f32_32x32x16_bf16 v[128:143], a[0:3], v[72:75], v[128:143]
    s_add_u32 m0, s10, 1024
    s_add_u32 s86, s86, 7168
    buffer_load_dwordx4 v5, s[32:35], s86 offen lds
    v_add_u32 v12, 4294836224, v8
    ds_read_b64_tr_b16 a[24:25], v12
    ds_read_b64_tr_b16 a[26:27], v12 offset:512
    ds_read_b64_tr_b16 a[12:13], v9 offset:16384
    ds_read_b64_tr_b16 a[14:15], v9 offset:16896
    v_cvt_pk_bf16_f32 v187, v182, v183
    buffer_store_dwordx4 v[184:187], v2, s[28:31], s5 offen offset:0
    v_mul_f32 v152, v152, v13
    v_mul_f32 v153, v153, v13
    s_waitcnt lgkmcnt(8)
    v_mfma_f32_32x32x16_bf16 v[128:143], a[4:7], v[76:79], v[128:143]
    s_waitcnt lgkmcnt(6)
    v_mfma_f32_16x16x32_bf16 v[160:163], v[164:167], a[20:23], v[160:163]
    v_add_u32 v12, 4294844416, v8
    ds_read_b64_tr_b16 a[20:21], v12
    ds_read_b64_tr_b16 a[22:23], v12 offset:512
    ds_read_b64_tr_b16 a[16:17], v10 offset:16384
    ds_read_b64_tr_b16 a[18:19], v10 offset:16896
    v_mul_f32 v154, v154, v13
    v_mul_f32 v155, v155, v13
    v_mul_f32 v156, v156, v13
    v_mul_f32 v157, v157, v13
    v_mul_f32 v158, v158, v13
    s_waitcnt lgkmcnt(8)
    v_mfma_f32_32x32x16_bf16 v[128:143], a[8:11], v[80:83], v[128:143]
    s_waitcnt lgkmcnt(6)
    v_mfma_f32_16x16x32_bf16 v[160:163], v[164:167], a[24:27], v[160:163]
    ds_read_b64_tr_b16 a[0:1], v11 offset:16384
    ds_read_b64_tr_b16 a[2:3], v11 offset:16896
    v_mul_f32 v159, v159, v13
    v_exp_f32 v176, v152
    v_exp_f32 v177, v153
    s_waitcnt lgkmcnt(6)
    v_mfma_f32_32x32x16_bf16 v[128:143], a[12:15], v[84:87], v[128:143]
    s_add_u32 m0, s10, 2048
    s_add_u32 s86, s86, 7168
    buffer_load_dwordx4 v5, s[32:35], s86 offen lds
    s_waitcnt lgkmcnt(4)
    v_mfma_f32_16x16x32_bf16 v[160:163], v[164:167], a[20:23], v[160:163]
    v_add_u32 v8, 4294836224, v8
    ds_read_b64_tr_b16 a[4:5], v8 offset:0
    ds_read_b64_tr_b16 a[6:7], v8 offset:512
    v_exp_f32 v178, v154
    v_exp_f32 v179, v155
    v_exp_f32 v180, v156
    s_waitcnt lgkmcnt(4)
    v_mfma_f32_32x32x16_bf16 v[128:143], a[16:19], v[88:91], v[128:143]
    v_lshlrev_b32 v196, 7, v1
    s_mov_b64 exec, 255
    buffer_load_dword v200, v196, s[28:31], s7 offen
    s_mov_b64 exec, -1
    v_add_u32 v9, 4294836224, v9
    ds_read_b64_tr_b16 a[8:9], v9 offset:0
    ds_read_b64_tr_b16 a[10:11], v9 offset:512
    v_exp_f32 v181, v157
    v_exp_f32 v182, v158
    s_waitcnt lgkmcnt(4)
    v_mfma_f32_32x32x16_bf16 v[128:143], a[0:3], v[92:95], v[128:143]
    v_add_u32 v10, 4294836224, v10
    ds_read_b64_tr_b16 a[12:13], v10 offset:0
    ds_read_b64_tr_b16 a[14:15], v10 offset:512
    v_exp_f32 v183, v159
    v_add_f32 v176, 1.0, v176
    v_add_f32 v177, 1.0, v177
    v_add_f32 v178, 1.0, v178
    s_waitcnt lgkmcnt(4)
    v_mfma_f32_32x32x16_bf16 v[128:143], a[4:7], v[96:99], v[128:143]
    s_add_u32 m0, s10, 3072
    s_add_u32 s86, s86, 7168
    buffer_load_dwordx4 v5, s[32:35], s86 offen lds
    ds_write_b32 v171, v160 offset:0
    v_add_u32 v11, 4294836224, v11
    ds_read_b64_tr_b16 a[16:17], v11 offset:0
    ds_read_b64_tr_b16 a[18:19], v11 offset:512
    v_add_f32 v179, 1.0, v179
    v_add_f32 v180, 1.0, v180
    v_add_f32 v181, 1.0, v181
    v_add_f32 v182, 1.0, v182
    v_add_f32 v183, 1.0, v183
    s_waitcnt lgkmcnt(5)
    v_mfma_f32_32x32x16_bf16 v[128:143], a[8:11], v[100:103], v[128:143]
    ds_read_b64_tr_b16 a[0:1], v8 offset:8192
    ds_read_b64_tr_b16 a[2:3], v8 offset:8704
    v_rcp_f32 v176, v176
    v_rcp_f32 v177, v177
    s_waitcnt lgkmcnt(5)
    v_mfma_f32_32x32x16_bf16 v[128:143], a[12:15], v[104:107], v[128:143]
    ds_read_b64_tr_b16 a[4:5], v9 offset:8192
    ds_read_b64_tr_b16 a[6:7], v9 offset:8704
    v_rcp_f32 v178, v178
    v_rcp_f32 v179, v179
    v_rcp_f32 v180, v180
    s_waitcnt lgkmcnt(4)
    v_mfma_f32_32x32x16_bf16 v[128:143], a[16:19], v[108:111], v[128:143]
    ds_read_b64_tr_b16 a[8:9], v10 offset:8192
    ds_read_b64_tr_b16 a[10:11], v10 offset:8704
    v_rcp_f32 v181, v181
    v_rcp_f32 v182, v182
    s_waitcnt lgkmcnt(4)
    v_mfma_f32_32x32x16_bf16 v[128:143], a[0:3], v[112:115], v[128:143]
    s_waitcnt vmcnt(7)
    s_barrier
    s_and_b32 s42, s2, 7
    s_lshl_b32 s42, s42, 7
    v_and_b32 v173, 31, v1
    v_lshlrev_b32 v173, 10, v173
    v_add_u32 v173, s42, v173
    v_and_b32 v174, 15, v1
    v_lshlrev_b32 v174, 7, v174
    v_add_u32 v174, 30720, v174
    v_cmp_gt_u32 vcc, 32, v1
    s_nop 1
    v_cndmask_b32 v173, v174, v173, vcc
    v_add_u32 v173, 13238272, v173
    buffer_load_dwordx2 v[174:175], v173, s[28:31], 0 offen sc1
    ds_read_b128 v[224:227], v172 offset:0
    ds_read_b64_tr_b16 a[12:13], v11 offset:8192
    ds_read_b64_tr_b16 a[14:15], v11 offset:8704
    v_rcp_f32 v183, v183
    v_mul_f32 v176, v152, v176
    v_mul_f32 v177, v153, v177
    v_mul_f32 v178, v154, v178
    s_waitcnt lgkmcnt(5)
    v_mfma_f32_32x32x16_bf16 v[128:143], a[4:7], v[116:119], v[128:143]
    s_lshl_b32 s10, s37, 13
    s_add_u32 s10, s10, s18
    s_lshl_b32 s17, s38, 12
    s_add_u32 s10, s10, s17
    s_mul_i32 s86, s37, 100352
    s_lshl_b32 s17, s82, 7
    s_add_u32 s86, s86, s17
    s_mul_i32 s17, s38, 28672
    s_add_u32 s86, s86, s17
    s_mov_b32 s87, 0
    s_add_u32 s86, s86, s87
    s_add_u32 m0, s10, 0
    s_nop 0
    buffer_load_dwordx4 v5, s[88:91], s86 offen lds
    v_add_u32 v12, 65536, v7
    ds_read_b64_tr_b16 a[20:21], v12
    ds_read_b64_tr_b16 a[22:23], v12 offset:256
    v_add_u32 v8, 65536, v7
    ds_read_b64_tr_b16 a[16:17], v8 offset:0
    ds_read_b64_tr_b16 a[18:19], v8 offset:256
    v_mul_f32 v179, v155, v179
    v_mul_f32 v180, v156, v180
    v_mul_f32 v181, v157, v181
    v_mul_f32 v182, v158, v182
    v_mul_f32 v183, v159, v183
    s_waitcnt lgkmcnt(7)
    v_mfma_f32_32x32x16_bf16 v[128:143], a[8:11], v[120:123], v[128:143]
    s_waitcnt lgkmcnt(6)
    v_add_f32 v224, v224, v225
    v_add_f32 v226, v226, v227
    v_add_f32 v224, v224, v226
    v_cvt_pk_bf16_f32 v225, v224, v224
    v_add_u32 v12, 69632, v7
    ds_read_b64_tr_b16 a[24:25], v12
    ds_read_b64_tr_b16 a[26:27], v12 offset:256
    v_xor_b32 v9, 1024, v7
    v_add_u32 v9, 65536, v9
    ds_read_b64_tr_b16 a[0:1], v9 offset:0
    ds_read_b64_tr_b16 a[2:3], v9 offset:256
    v_cvt_pk_bf16_f32 v188, v176, v177
    v_cvt_pk_bf16_f32 v189, v178, v179
    v_cvt_pk_bf16_f32 v190, v180, v181
    v_cvt_pk_bf16_f32 v191, v182, v183
    buffer_store_dwordx4 v[188:191], v2, s[28:31], s5 offen offset:1024
    s_waitcnt lgkmcnt(8)
    v_mfma_f32_32x32x16_bf16 v[128:143], a[12:15], v[124:127], v[128:143]
    v_lshlrev_b32 v225, 16, v225
    v_sub_f32 v225, v224, v225
    v_cvt_pk_bf16_f32 v168, v224, v225
    v_and_b32 v169, 0xffff, v168
    s_waitcnt lgkmcnt(6)
    v_mfma_f32_16x16x32_bf16 v[160:163], v[164:167], a[20:23], 0
    v_add_u32 v12, 73728, v7
    ds_read_b64_tr_b16 a[20:21], v12
    ds_read_b64_tr_b16 a[22:23], v12 offset:256
    ds_read_b64_tr_b16 a[4:5], v8 offset:4096
    ds_read_b64_tr_b16 a[6:7], v8 offset:4352
    v_mfma_f32_32x32x8bf16_1k v[128:143], v[168:169], v[14:15], v[128:143]
    s_waitcnt lgkmcnt(8)
    v_mfma_f32_32x32x16_bf16 v[144:159], a[16:19], v[16:19], 0
    s_add_u32 m0, s10, 1024
    s_add_u32 s86, s86, 7168
    buffer_load_dwordx4 v5, s[88:91], s86 offen lds
    s_waitcnt lgkmcnt(6)
    v_mfma_f32_16x16x32_bf16 v[160:163], v[164:167], a[24:27], v[160:163]
    v_add_u32 v12, 77824, v7
    ds_read_b64_tr_b16 a[24:25], v12
    ds_read_b64_tr_b16 a[26:27], v12 offset:256
    ds_read_b64_tr_b16 a[8:9], v9 offset:4096
    ds_read_b64_tr_b16 a[10:11], v9 offset:4352
    s_waitcnt lgkmcnt(8)
    v_mfma_f32_32x32x16_bf16 v[144:159], a[0:3], v[20:23], v[144:159]
    s_waitcnt lgkmcnt(6)
    v_mfma_f32_16x16x32_bf16 v[160:163], v[164:167], a[20:23], v[160:163]
    v_add_u32 v12, 81920, v7
    ds_read_b64_tr_b16 a[20:21], v12
    ds_read_b64_tr_b16 a[22:23], v12 offset:256
    ds_read_b64_tr_b16 a[12:13], v8 offset:8192
    ds_read_b64_tr_b16 a[14:15], v8 offset:8448
    s_waitcnt lgkmcnt(8)
    v_mfma_f32_32x32x16_bf16 v[144:159], a[4:7], v[32:35], v[144:159]
    s_waitcnt lgkmcnt(6)
    v_mfma_f32_16x16x32_bf16 v[160:163], v[164:167], a[24:27], v[160:163]
    v_add_u32 v12, 86016, v7
    ds_read_b64_tr_b16 a[24:25], v12
    ds_read_b64_tr_b16 a[26:27], v12 offset:256
    ds_read_b64_tr_b16 a[16:17], v9 offset:8192
    ds_read_b64_tr_b16 a[18:19], v9 offset:8448
    v_mul_f32 v128, v128, v13
    v_mul_f32 v129, v129, v13
    v_mul_f32 v130, v130, v13
    v_mul_f32 v131, v131, v13
    v_mul_f32 v132, v132, v13
    v_mul_f32 v133, v133, v13
    v_mul_f32 v134, v134, v13
    v_mul_f32 v135, v135, v13
    v_exp_f32 v176, v128
    s_waitcnt lgkmcnt(8)
    v_mfma_f32_32x32x16_bf16 v[144:159], a[8:11], v[36:39], v[144:159]
    s_add_u32 m0, s10, 2048
    s_add_u32 s86, s86, 7168
    buffer_load_dwordx4 v5, s[88:91], s86 offen lds
    s_waitcnt lgkmcnt(6)
    v_mfma_f32_16x16x32_bf16 v[160:163], v[164:167], a[20:23], v[160:163]
    v_add_u32 v12, 90112, v7
    ds_read_b64_tr_b16 a[20:21], v12
    ds_read_b64_tr_b16 a[22:23], v12 offset:256
    ds_read_b64_tr_b16 a[0:1], v8 offset:12288
    ds_read_b64_tr_b16 a[2:3], v8 offset:12544
    v_exp_f32 v177, v129
    v_exp_f32 v178, v130
    v_exp_f32 v179, v131
    v_exp_f32 v180, v132
    s_waitcnt lgkmcnt(8)
    v_mfma_f32_32x32x16_bf16 v[144:159], a[12:15], v[48:51], v[144:159]
    s_waitcnt lgkmcnt(6)
    v_mfma_f32_16x16x32_bf16 v[160:163], v[164:167], a[24:27], v[160:163]
    ds_read_b64_tr_b16 a[4:5], v9 offset:12288
    ds_read_b64_tr_b16 a[6:7], v9 offset:12544
    v_exp_f32 v181, v133
    v_exp_f32 v182, v134
    v_exp_f32 v183, v135
    v_add_f32 v176, 1.0, v176
    v_add_f32 v177, 1.0, v177
    v_add_f32 v178, 1.0, v178
    v_add_f32 v179, 1.0, v179
    s_waitcnt lgkmcnt(6)
    v_mfma_f32_32x32x16_bf16 v[144:159], a[16:19], v[52:55], v[144:159]
    s_waitcnt lgkmcnt(4)
    v_mfma_f32_16x16x32_bf16 v[160:163], v[164:167], a[20:23], v[160:163]
    ds_read_b64_tr_b16 a[8:9], v8 offset:16384
    ds_read_b64_tr_b16 a[10:11], v8 offset:16640
    v_add_f32 v180, 1.0, v180
    v_add_f32 v181, 1.0, v181
    v_add_f32 v182, 1.0, v182
    v_add_f32 v183, 1.0, v183
    v_rcp_f32 v176, v176
    v_rcp_f32 v177, v177
    s_waitcnt lgkmcnt(4)
    v_mfma_f32_32x32x16_bf16 v[144:159], a[0:3], v[64:67], v[144:159]
    s_add_u32 m0, s10, 3072
    s_add_u32 s86, s86, 7168
    buffer_load_dwordx4 v5, s[88:91], s86 offen lds
    ds_read_b64_tr_b16 a[12:13], v9 offset:16384
    ds_read_b64_tr_b16 a[14:15], v9 offset:16640
    v_rcp_f32 v178, v178
    v_rcp_f32 v179, v179
    v_rcp_f32 v180, v180
    v_rcp_f32 v181, v181
    v_rcp_f32 v182, v182
    s_waitcnt lgkmcnt(4)
    v_mfma_f32_32x32x16_bf16 v[144:159], a[4:7], v[68:71], v[144:159]
    ds_write_b32 v171, v160 offset:1024
    ds_read_b64_tr_b16 a[16:17], v8 offset:20480
    ds_read_b64_tr_b16 a[18:19], v8 offset:20736
    v_rcp_f32 v183, v183
    v_mul_f32 v176, v128, v176
    v_mul_f32 v177, v129, v177
    v_mul_f32 v178, v130, v178
    v_mul_f32 v179, v131, v179
    v_mul_f32 v180, v132, v180
    v_mul_f32 v181, v133, v181
    v_mul_f32 v182, v134, v182
    s_waitcnt lgkmcnt(5)
    v_mfma_f32_32x32x16_bf16 v[144:159], a[8:11], v[80:83], v[144:159]
    ds_read_b64_tr_b16 a[0:1], v9 offset:20480
    ds_read_b64_tr_b16 a[2:3], v9 offset:20736
    v_mul_f32 v183, v135, v183
    v_cvt_pk_bf16_f32 v184, v176, v177
    v_cvt_pk_bf16_f32 v185, v178, v179
    v_cvt_pk_bf16_f32 v186, v180, v181
    v_cvt_pk_bf16_f32 v187, v182, v183
    buffer_store_dwordx4 v[184:187], v2, s[28:31], s6 offen offset:0
    v_mul_f32 v136, v136, v13
    v_mul_f32 v137, v137, v13
    v_mul_f32 v138, v138, v13
    v_mul_f32 v139, v139, v13
    s_waitcnt lgkmcnt(5)
    v_mfma_f32_32x32x16_bf16 v[144:159], a[12:15], v[84:87], v[144:159]
    ds_read_b64_tr_b16 a[4:5], v8 offset:24576
    ds_read_b64_tr_b16 a[6:7], v8 offset:24832
    v_mul_f32 v140, v140, v13
    v_mul_f32 v141, v141, v13
    v_mul_f32 v142, v142, v13
    v_mul_f32 v143, v143, v13
    v_exp_f32 v176, v136
    v_exp_f32 v177, v137
    s_waitcnt lgkmcnt(4)
    v_mfma_f32_32x32x16_bf16 v[144:159], a[16:19], v[96:99], v[144:159]
    s_barrier
    ds_read_b64_tr_b16 a[8:9], v9 offset:24576
    ds_read_b64_tr_b16 a[10:11], v9 offset:24832
    v_exp_f32 v178, v138
    v_exp_f32 v179, v139
    v_exp_f32 v180, v140
    v_exp_f32 v181, v141
    v_exp_f32 v182, v142
    s_waitcnt lgkmcnt(4)
    v_mfma_f32_32x32x16_bf16 v[144:159], a[0:3], v[100:103], v[144:159]
    ds_read_b128 v[224:227], v172 offset:1024
    s_waitcnt lgkmcnt(0)
    v_add_f32 v224, v224, v225
    v_add_f32 v226, v226, v227
    v_mfma_f32_32x32x16_bf16 v[144:159], a[4:7], v[112:115], v[144:159]
    v_add_f32 v224, v224, v226
    v_mul_f32 v224, 0.5, v224
    v_cvt_pk_bf16_f32 v225, v224, v224
    v_lshlrev_b32 v225, 16, v225
    v_mfma_f32_32x32x16_bf16 v[144:159], a[8:11], v[116:119], v[144:159]
    v_sub_f32 v225, v224, v225
    v_cvt_pk_bf16_f32 v168, v224, v225
    v_and_b32 v169, 0xffff, v168
    s_nop 1
    v_mfma_f32_32x32x8bf16_1k v[144:159], v[168:169], v[14:15], v[144:159]
    v_exp_f32 v183, v143
    v_add_f32 v176, 1.0, v176
    v_add_f32 v177, 1.0, v177
    v_add_f32 v178, 1.0, v178
    v_add_f32 v179, 1.0, v179
    v_add_f32 v180, 1.0, v180
    v_add_f32 v181, 1.0, v181
    v_add_f32 v182, 1.0, v182
    v_add_f32 v183, 1.0, v183
    v_rcp_f32 v176, v176
    v_rcp_f32 v177, v177
    v_rcp_f32 v178, v178
    v_rcp_f32 v179, v179
    v_rcp_f32 v180, v180
    v_rcp_f32 v181, v181
    v_rcp_f32 v182, v182
    v_rcp_f32 v183, v183
    v_mul_f32 v176, v136, v176
    v_mul_f32 v177, v137, v177
    v_mul_f32 v178, v138, v178
    v_mul_f32 v179, v139, v179
    v_mul_f32 v180, v140, v180
    v_mul_f32 v181, v141, v181
    v_mul_f32 v182, v142, v182
    v_mul_f32 v183, v143, v183
    v_cvt_pk_bf16_f32 v188, v176, v177
    v_cvt_pk_bf16_f32 v189, v178, v179
    v_cvt_pk_bf16_f32 v190, v180, v181
    v_cvt_pk_bf16_f32 v191, v182, v183
    buffer_store_dwordx4 v[188:191], v2, s[28:31], s6 offen offset:1024
    s_lshl_b32 s84, s36, 11
    s_add_u32 s84, s84, 8192
    v_add_u32 v6, s84, v2
    ds_write_b128 v6, v[152:155] offset:0
    ds_write_b128 v6, v[156:159] offset:1024
    s_xor_b32 s84, s36, 4
    s_lshl_b32 s84, s84, 11
    s_add_u32 s84, s84, 8192
    v_add_u32 v6, s84, v2
    s_waitcnt lgkmcnt(0)
    s_barrier
    ds_read_b128 v[152:155], v6 offset:0
    ds_read_b128 v[156:159], v6 offset:1024
    s_waitcnt lgkmcnt(1)
    v_add_f32 v144, v144, v152
    v_add_f32 v145, v145, v153
    v_add_f32 v146, v146, v154
    v_add_f32 v147, v147, v155
    s_waitcnt lgkmcnt(0)
    v_add_f32 v148, v148, v156
    v_add_f32 v149, v149, v157
    v_add_f32 v150, v150, v158
    v_add_f32 v151, v151, v159
    v_mul_f32 v144, v144, v13
    v_mul_f32 v145, v145, v13
    v_mul_f32 v146, v146, v13
    v_mul_f32 v147, v147, v13
    v_mul_f32 v148, v148, v13
    v_mul_f32 v149, v149, v13
    v_mul_f32 v150, v150, v13
    v_mul_f32 v151, v151, v13
    v_exp_f32 v176, v144
    v_exp_f32 v177, v145
    v_exp_f32 v178, v146
    v_exp_f32 v179, v147
    v_exp_f32 v180, v148
    v_exp_f32 v181, v149
    v_exp_f32 v182, v150
    v_exp_f32 v183, v151
    v_add_f32 v176, 1.0, v176
    v_add_f32 v177, 1.0, v177
    v_add_f32 v178, 1.0, v178
    v_add_f32 v179, 1.0, v179
    v_add_f32 v180, 1.0, v180
    v_add_f32 v181, 1.0, v181
    v_add_f32 v182, 1.0, v182
    v_add_f32 v183, 1.0, v183
    v_rcp_f32 v176, v176
    v_rcp_f32 v177, v177
    v_rcp_f32 v178, v178
    v_rcp_f32 v179, v179
    v_rcp_f32 v180, v180
    v_rcp_f32 v181, v181
    v_rcp_f32 v182, v182
    v_rcp_f32 v183, v183
    v_mul_f32 v176, v144, v176
    v_mul_f32 v177, v145, v177
    v_mul_f32 v178, v146, v178
    v_mul_f32 v179, v147, v179
    v_mul_f32 v180, v148, v180
    v_mul_f32 v181, v149, v181
    v_mul_f32 v182, v150, v182
    v_mul_f32 v183, v151, v183
    v_cvt_pk_bf16_f32 v184, v176, v177
    v_cvt_pk_bf16_f32 v185, v178, v179
    v_cvt_pk_bf16_f32 v186, v180, v181
    v_cvt_pk_bf16_f32 v187, v182, v183
    buffer_store_dwordx4 v[184:187], v2, s[28:31], s7 offen offset:0
    s_waitcnt vmcnt(8)
    v_subrev_u32 v224, s57, v175
    v_cmp_ne_u32 vcc, s56, v174
    v_cmp_lt_u32 s[60:61], 15, v224
    s_nop 4
    s_or_b64 vcc, vcc, s[60:61]
    s_cmp_eq_u64 vcc, 0
    s_cbranch_scc1 L_px_f_ok
    s_mov_b32 s80, 0
L_px_f_spin:
    s_add_u32 s80, s80, 1
    s_cmp_gt_u32 s80, 1048576
    s_cbranch_scc1 L_end
    buffer_load_dwordx2 v[174:175], v173, s[28:31], 0 offen sc1
    s_waitcnt vmcnt(0)
    v_subrev_u32 v224, s57, v175
    v_cmp_ne_u32 vcc, s56, v174
    v_cmp_lt_u32 s[60:61], 15, v224
    s_nop 4
    s_or_b64 vcc, vcc, s[60:61]
    s_cmp_eq_u64 vcc, 0
    s_cbranch_scc0 L_px_f_spin
L_px_f_ok:
    v_cmp_ne_u32 vcc, s79, v175
    s_nop 4
    s_cmp_eq_u32 vcc_lo, 0
    s_cselect_b32 s79, 1, 0
    v_mov_b32 v224, s56
    v_mov_b32 v225, s57
    v_mov_b32 v226, 0
    s_waitcnt vmcnt(0)
    s_mov_b64 exec, 1
    s_cmp_eq_u32 s79, 1
    s_cbranch_scc1 L_fast_f
    buffer_wbl2 sc1
    s_waitcnt vmcnt(0)
    buffer_store_dwordx2 v[224:225], v226, s[28:31], s76 offen sc1
    s_branch L_pub_f
L_fast_f:
    buffer_store_dwordx2 v[224:225], v226, s[28:31], s76 offen
L_pub_f:
    s_mov_b64 exec, -1
    s_lshl_b32 s10, s37, 13
    s_add_u32 s10, s10, s19
    s_lshl_b32 s17, s38, 12
    s_add_u32 s10, s10, s17
    s_mul_i32 s86, s37, 401408
    s_lshl_b32 s17, s82, 7
    s_add_u32 s86, s86, s17
    s_mul_i32 s17, s38, 28672
    s_add_u32 s86, s86, s17
    s_add_u32 s87, s83, 2
    s_cmp_ge_u32 s87, 7
    s_cselect_b32 s17, 7, 0
    s_sub_u32 s87, s87, s17
    s_mul_i32 s87, s87, 57344
    s_add_u32 s86, s86, s87
    s_add_u32 m0, s10, 0
    s_nop 0
    buffer_load_dwordx4 v5, s[32:35], s86 offen lds
    s_add_u32 m0, s10, 1024
    s_add_u32 s86, s86, 7168
    buffer_load_dwordx4 v5, s[32:35], s86 offen lds
    s_add_u32 m0, s10, 2048
    s_add_u32 s86, s86, 7168
    buffer_load_dwordx4 v5, s[32:35], s86 offen lds
    s_add_u32 m0, s10, 3072
    s_add_u32 s86, s86, 7168
    buffer_load_dwordx4 v5, s[32:35], s86 offen lds
    s_and_b32 s42, s81, 3
    s_lshl_b32 s42, s42, 1
    s_add_u32 s42, s42, s38
    s_mul_i32 s42, s42, 7168
    s_mul_i32 s43, s37, 401408
    s_add_u32 s42, s42, s43
    s_lshl_b32 s43, s82, 7
    s_add_u32 s42, s42, s43
    s_add_u32 s43, s83, 4
    s_cmp_ge_u32 s43, 7
    s_cselect_b32 s17, 7, 0
    s_sub_u32 s43, s43, s17
    s_mul_i32 s43, s43, 57344
    s_add_u32 s42, s42, s43
    v_mul_u32_u24 v208, 896, v1
    s_mov_b64 exec, 0xff
    buffer_load_dword v209, v208, s[32:35], s42 offen
    s_mov_b64 exec, -1
L_phase_b:
    s_lshl_b32 s42, s81, 1
    s_add_u32 s42, s42, s38
    s_mul_i32 s50, s42, 143360
    s_lshl_b32 s43, s42, 7
    s_lshl_b32 s42, s42, 8
    s_add_u32 s42, s42, 13107200
    v_and_b32 v173, 31, v1
    v_lshl_add_u32 v173, v173, 3, s42
    buffer_load_dwordx2 v[174:175], v173, s[28:31], 0 offen sc1
    s_lshl_b32 s42, s37, 3
    s_add_u32 s42, s42, s43
    s_add_u32 s42, s42, 13123584
    v_mov_b32 v94, s42
    s_barrier
    s_lshl_b32 s42, s37, 2
    s_lshl_b32 s62, 0x000f0000, s42
    s_mov_b32 s63, 0
    s_mov_b32 s58, 1
    s_mov_b32 s59, 0
    s_lshl_b32 s48, s83, 12
    s_mul_i32 s43, s37, 28672
    s_add_u32 s42, s50, s43
    v_add_u32 v3, s42, v2
    s_mul_i32 s50, s37, 21504
    s_sub_u32 s50, 114688, s50
    s_mov_b32 s54, 0xbef5fdf0
    v_lshrrev_b32 v92, 3, v1
    v_mul_u32_u24 v4, 896, v92
    v_and_b32 v93, 7, v1
    v_lshl_add_u32 v4, v93, 4, v4
    v_lshlrev_b32 v93, 1, v93
    v_xor_b32 v93, v93, v92
    v_lshlrev_b32 v14, 8, v92
    v_lshl_add_u32 v14, v93, 4, v14
    s_lshl_b32 s42, s37, 11
    s_cmp_eq_u32 s38, 0
    s_cselect_b32 s43, s19, 32768
    s_add_u32 s42, s42, s43
    v_add_u32 v14, s42, v14
    v_xor_b32 v15, 16, v14
    s_lshl_b32 s42, s37, 13
    s_add_u32 s42, s42, s43
    v_and_b32 v92, 31, v1
    v_lshlrev_b32 v10, 8, v92
    v_and_b32 v92, 7, v1
    v_lshrrev_b32 v93, 5, v1
    v_xor_b32 v92, v92, v93
    v_lshl_add_u32 v10, v92, 4, v10
    v_add_u32 v10, s42, v10
    v_xor_b32 v11, 32, v10
    v_xor_b32 v12, 64, v10
    v_xor_b32 v13, 96, v10
    s_lshl_b32 s51, s81, 3
    s_add_u32 s51, s51, s36
    s_mul_i32 s51, s51, 7168
    s_lshl_b32 s42, s82, 7
    s_add_u32 s51, s51, s42
    v_lshrrev_b32 v224, 5, v1
    v_mul_u32_u24 v6, 512, v224
    v_bfe_u32 v224, v1, 2, 2
    v_lshl_add_u32 v6, v224, 7, v6
    v_lshrrev_b32 v224, 1, v224
    v_lshlrev_b32 v224, 6, v224
    v_bfe_u32 v225, v1, 4, 1
    v_lshlrev_b32 v225, 5, v225
    v_and_b32 v226, 3, v1
    v_lshl_add_u32 v225, v226, 3, v225
    v_xor_b32 v224, v224, v225
    v_add_u32 v6, v6, v224
    v_xor_b32 v7, 64, v6
    s_mov_b32 s24, s96
    s_mov_b32 s25, s97
    s_mov_b32 s26, 1835008
    s_mov_b32 s27, 0x20000
    s_lshl_b32 s11, s37, 3
    s_lshr_b32 s11, 117835012, s11
    s_and_b32 s11, s11, 31
    s_lshl_b32 s11, s11, 13
    v_add_u32 v8, s11, v6
    v_add_u32 v9, s11, v7
    ds_read_b64_tr_b16 a[0:1], v8 offset:0
    ds_read_b64_tr_b16 a[2:3], v8 offset:1024
    ds_read_b64_tr_b16 a[4:5], v9 offset:0
    ds_read_b64_tr_b16 a[6:7], v9 offset:1024
    ds_read_b64_tr_b16 a[8:9], v8 offset:2048
    ds_read_b64_tr_b16 a[10:11], v8 offset:3072
    ds_read_b64_tr_b16 a[12:13], v9 offset:2048
    ds_read_b64_tr_b16 a[14:15], v9 offset:3072
    s_lshl_b32 s10, s37, 3
    s_lshr_b32 s10, 131347, s10
    s_and_b32 s10, s10, 31
    s_lshl_b32 s10, s10, 13
    s_lshl_b32 s17, s38, 12
    s_add_u32 s10, s10, s17
    s_mul_i32 s86, s37, 401408
    s_lshl_b32 s17, s82, 7
    s_add_u32 s86, s86, s17
    s_mul_i32 s17, s38, 28672
    s_add_u32 s86, s86, s17
    s_add_u32 s87, s83, 3
    s_cmp_ge_u32 s87, 7
    s_cselect_b32 s17, 7, 0
    s_sub_u32 s87, s87, s17
    s_mul_i32 s87, s87, 57344
    s_add_u32 s86, s86, s87
    s_add_u32 m0, s10, 0
    s_nop 0
    buffer_load_dwordx4 v5, s[32:35], s86 offen lds
    s_add_u32 m0, s10, 1024
    s_add_u32 s86, s86, 7168
    buffer_load_dwordx4 v5, s[32:35], s86 offen lds
    s_add_u32 m0, s10, 2048
    s_add_u32 s86, s86, 7168
    buffer_load_dwordx4 v5, s[32:35], s86 offen lds
    s_add_u32 m0, s10, 3072
    s_add_u32 s86, s86, 7168
    buffer_load_dwordx4 v5, s[32:35], s86 offen lds
    s_waitcnt vmcnt(4)
    v_cmp_ne_u64 vcc, s[56:57], v[174:175]
    s_nop 4
    s_and_b64 vcc, vcc, s[62:63]
    s_cmp_eq_u64 vcc, 0
    s_cbranch_scc1 L_fa_ok
    s_mov_b32 s80, 0
L_fa_spin:
    s_add_u32 s80, s80, 1
    s_cmp_gt_u32 s80, 1048576
    s_cbranch_scc1 L_end
    s_sleep 2
    buffer_load_dwordx2 v[174:175], v173, s[28:31], 0 offen sc1
    s_waitcnt vmcnt(0)
    v_cmp_ne_u64 vcc, s[56:57], v[174:175]
    s_nop 4
    s_and_b64 vcc, vcc, s[62:63]
    s_cmp_eq_u64 vcc, 0
    s_cbranch_scc0 L_fa_spin
L_fa_ok:
    s_cmp_eq_u32 s79, 1
    s_cbranch_scc1 L_noinv_fa
    buffer_inv sc1
    s_waitcnt vmcnt(0)
L_noinv_fa:
    buffer_load_dwordx4 v[16:19], v3, s[28:31], s48 offen offset:0 sc1
    buffer_load_dwordx4 v[20:23], v3, s[28:31], s48 offen offset:1024 sc1
    buffer_load_dwordx4 v[24:27], v3, s[28:31], s48 offen offset:2048 sc1
    s_waitcnt vmcnt(2) lgkmcnt(6)
    v_mfma_f32_32x32x16_bf16 v[128:143], a[0:3], v[16:19], 0
    s_waitcnt lgkmcnt(4)
    v_mfma_f32_32x32x16_bf16 v[144:159], a[4:7], v[16:19], 0
    buffer_load_dwordx4 v[28:31], v3, s[28:31], s48 offen offset:3072 sc1
    s_add_u32 s48, s48, 4096
    s_cmp_eq_u32 s48, 28672
    s_cselect_b32 s48, 0, s48
    buffer_load_dwordx4 v[32:35], v3, s[28:31], s48 offen offset:0 sc1
    buffer_load_dwordx4 v[36:39], v3, s[28:31], s48 offen offset:1024 sc1
    ds_read_b64_tr_b16 a[16:17], v8 offset:4096
    ds_read_b64_tr_b16 a[18:19], v8 offset:5120
    ds_read_b64_tr_b16 a[20:21], v9 offset:4096
    ds_read_b64_tr_b16 a[22:23], v9 offset:5120
    s_waitcnt vmcnt(4) lgkmcnt(6)
    v_mfma_f32_32x32x16_bf16 v[128:143], a[8:11], v[20:23], v[128:143]
    s_waitcnt lgkmcnt(4)
    v_mfma_f32_32x32x16_bf16 v[144:159], a[12:15], v[20:23], v[144:159]
    buffer_load_dwordx4 v[40:43], v3, s[28:31], s48 offen offset:2048 sc1
    ds_read_b64_tr_b16 a[0:1], v8 offset:6144
    ds_read_b64_tr_b16 a[2:3], v8 offset:7168
    ds_read_b64_tr_b16 a[4:5], v9 offset:6144
    ds_read_b64_tr_b16 a[6:7], v9 offset:7168
    s_waitcnt vmcnt(4) lgkmcnt(6)
    v_mfma_f32_32x32x16_bf16 v[128:143], a[16:19], v[24:27], v[128:143]
    s_waitcnt lgkmcnt(4)
    v_mfma_f32_32x32x16_bf16 v[144:159], a[20:23], v[24:27], v[144:159]
    buffer_load_dwordx4 v[44:47], v3, s[28:31], s48 offen offset:3072 sc1
    s_add_u32 s48, s48, 4096
    s_cmp_eq_u32 s48, 28672
    s_cselect_b32 s48, 0, s48
    s_lshl_b32 s11, s37, 3
    s_lshr_b32 s11, 235736067, s11
    s_and_b32 s11, s11, 31
    s_lshl_b32 s11, s11, 13
    v_add_u32 v8, s11, v6
    v_add_u32 v9, s11, v7
    ds_read_b64_tr_b16 a[8:9], v8 offset:0
    ds_read_b64_tr_b16 a[10:11], v8 offset:1024
    ds_read_b64_tr_b16 a[12:13], v9 offset:0
    ds_read_b64_tr_b16 a[14:15], v9 offset:1024
    s_waitcnt vmcnt(4) lgkmcnt(6)
    v_mfma_f32_32x32x16_bf16 v[128:143], a[0:3], v[28:31], v[128:143]
    s_waitcnt lgkmcnt(4)
    v_mfma_f32_32x32x16_bf16 v[144:159], a[4:7], v[28:31], v[144:159]
    buffer_load_dwordx4 v[16:19], v3, s[28:31], s48 offen offset:0 sc1
    ds_read_b64_tr_b16 a[16:17], v8 offset:2048
    ds_read_b64_tr_b16 a[18:19], v8 offset:3072
    ds_read_b64_tr_b16 a[20:21], v9 offset:2048
    ds_read_b64_tr_b16 a[22:23], v9 offset:3072
    s_waitcnt vmcnt(4) lgkmcnt(6)
    v_mfma_f32_32x32x16_bf16 v[128:143], a[8:11], v[32:35], v[128:143]
    s_waitcnt lgkmcnt(4)
    v_mfma_f32_32x32x16_bf16 v[144:159], a[12:15], v[32:35], v[144:159]
    buffer_load_dwordx4 v[20:23], v3, s[28:31], s48 offen offset:1024 sc1
    ds_read_b64_tr_b16 a[0:1], v8 offset:4096
    ds_read_b64_tr_b16 a[2:3], v8 offset:5120
    ds_read_b64_tr_b16 a[4:5], v9 offset:4096
    ds_read_b64_tr_b16 a[6:7], v9 offset:5120
    s_waitcnt vmcnt(4) lgkmcnt(6)
    v_mfma_f32_32x32x16_bf16 v[128:143], a[16:19], v[36:39], v[128:143]
    s_waitcnt lgkmcnt(4)
    v_mfma_f32_32x32x16_bf16 v[144:159], a[20:23], v[36:39], v[144:159]
    buffer_load_dwordx4 v[24:27], v3, s[28:31], s48 offen offset:2048 sc1
    ds_read_b64_tr_b16 a[8:9], v8 offset:6144
    ds_read_b64_tr_b16 a[10:11], v8 offset:7168
    ds_read_b64_tr_b16 a[12:13], v9 offset:6144
    ds_read_b64_tr_b16 a[14:15], v9 offset:7168
    s_waitcnt vmcnt(4) lgkmcnt(6)
    v_mfma_f32_32x32x16_bf16 v[128:143], a[0:3], v[40:43], v[128:143]
    s_waitcnt lgkmcnt(4)
    v_mfma_f32_32x32x16_bf16 v[144:159], a[4:7], v[40:43], v[144:159]
    buffer_load_dwordx4 v[28:31], v3, s[28:31], s48 offen offset:3072 sc1
    s_add_u32 s48, s48, 4096
    s_cmp_eq_u32 s48, 28672
    s_cselect_b32 s48, 0, s48
    s_barrier
    s_lshl_b32 s11, s37, 13
    s_add_u32 s11, s11, s19
    v_add_u32 v8, s11, v6
    v_add_u32 v9, s11, v7
    ds_read_b64_tr_b16 a[16:17], v8 offset:0
    ds_read_b64_tr_b16 a[18:19], v8 offset:1024
    ds_read_b64_tr_b16 a[20:21], v9 offset:0
    ds_read_b64_tr_b16 a[22:23], v9 offset:1024
    s_waitcnt vmcnt(4) lgkmcnt(6)
    v_mfma_f32_32x32x16_bf16 v[128:143], a[8:11], v[44:47], v[128:143]
    s_lshl_b32 s10, s37, 3
    s_lshr_b32 s10, 117835012, s10
    s_and_b32 s10, s10, 31
    s_lshl_b32 s10, s10, 13
    s_lshl_b32 s17, s38, 12
    s_add_u32 s10, s10, s17
    s_mul_i32 s86, s37, 401408
    s_lshl_b32 s17, s82, 7
    s_add_u32 s86, s86, s17
    s_mul_i32 s17, s38, 28672
    s_add_u32 s86, s86, s17
    s_add_u32 s87, s83, 4
    s_cmp_ge_u32 s87, 7
    s_cselect_b32 s17, 7, 0
    s_sub_u32 s87, s87, s17
    s_mul_i32 s87, s87, 57344
    s_add_u32 s86, s86, s87
    s_add_u32 m0, s10, 0
    s_nop 0
    buffer_load_dwordx4 v5, s[32:35], s86 offen lds
    s_add_u32 m0, s10, 1024
    s_add_u32 s86, s86, 7168
    buffer_load_dwordx4 v5, s[32:35], s86 offen lds
    s_waitcnt lgkmcnt(4)
    v_mfma_f32_32x32x16_bf16 v[144:159], a[12:15], v[44:47], v[144:159]
    buffer_load_dwordx4 v[32:35], v3, s[28:31], s48 offen offset:0 sc1
    ds_read_b64_tr_b16 a[0:1], v8 offset:2048
    ds_read_b64_tr_b16 a[2:3], v8 offset:3072
    ds_read_b64_tr_b16 a[4:5], v9 offset:2048
    ds_read_b64_tr_b16 a[6:7], v9 offset:3072
    s_waitcnt vmcnt(6) lgkmcnt(6)
    v_mfma_f32_32x32x16_bf16 v[128:143], a[16:19], v[16:19], v[128:143]
    s_add_u32 m0, s10, 2048
    s_add_u32 s86, s86, 7168
    buffer_load_dwordx4 v5, s[32:35], s86 offen lds
    s_add_u32 m0, s10, 3072
    s_add_u32 s86, s86, 7168
    buffer_load_dwordx4 v5, s[32:35], s86 offen lds
    s_waitcnt lgkmcnt(4)
    v_mfma_f32_32x32x16_bf16 v[144:159], a[20:23], v[16:19], v[144:159]
    buffer_load_dwordx4 v[36:39], v3, s[28:31], s48 offen offset:1024 sc1
    ds_read_b64_tr_b16 a[8:9], v8 offset:4096
    ds_read_b64_tr_b16 a[10:11], v8 offset:5120
    ds_read_b64_tr_b16 a[12:13], v9 offset:4096
    ds_read_b64_tr_b16 a[14:15], v9 offset:5120
    s_waitcnt vmcnt(8) lgkmcnt(6)
    v_mfma_f32_32x32x16_bf16 v[128:143], a[0:3], v[20:23], v[128:143]
    s_waitcnt lgkmcnt(4)
    v_mfma_f32_32x32x16_bf16 v[144:159], a[4:7], v[20:23], v[144:159]
    buffer_load_dwordx4 v[40:43], v3, s[28:31], s48 offen offset:2048 sc1
    ds_read_b64_tr_b16 a[16:17], v8 offset:6144
    ds_read_b64_tr_b16 a[18:19], v8 offset:7168
    ds_read_b64_tr_b16 a[20:21], v9 offset:6144
    ds_read_b64_tr_b16 a[22:23], v9 offset:7168
    s_waitcnt vmcnt(8) lgkmcnt(6)
    v_mfma_f32_32x32x16_bf16 v[128:143], a[8:11], v[24:27], v[128:143]
    s_waitcnt lgkmcnt(4)
    v_mfma_f32_32x32x16_bf16 v[144:159], a[12:15], v[24:27], v[144:159]
    buffer_load_dwordx4 v[44:47], v3, s[28:31], s48 offen offset:3072 sc1
    s_add_u32 s48, s48, 4096
    s_cmp_eq_u32 s48, 28672
    s_cselect_b32 s48, 0, s48
    s_lshl_b32 s11, s37, 3
    s_lshr_b32 s11, 131347, s11
    s_and_b32 s11, s11, 31
    s_lshl_b32 s11, s11, 13
    v_add_u32 v8, s11, v6
    v_add_u32 v9, s11, v7
    ds_read_b64_tr_b16 a[0:1], v8 offset:0
    ds_read_b64_tr_b16 a[2:3], v8 offset:1024
    ds_read_b64_tr_b16 a[4:5], v9 offset:0
    ds_read_b64_tr_b16 a[6:7], v9 offset:1024
    s_waitcnt vmcnt(8) lgkmcnt(6)
    v_mfma_f32_32x32x16_bf16 v[128:143], a[16:19], v[28:31], v[128:143]
    s_waitcnt lgkmcnt(4)
    v_mfma_f32_32x32x16_bf16 v[144:159], a[20:23], v[28:31], v[144:159]
    buffer_load_dwordx4 v[16:19], v3, s[28:31], s48 offen offset:0 sc1
    ds_read_b64_tr_b16 a[8:9], v8 offset:2048
    ds_read_b64_tr_b16 a[10:11], v8 offset:3072
    ds_read_b64_tr_b16 a[12:13], v9 offset:2048
    ds_read_b64_tr_b16 a[14:15], v9 offset:3072
    s_waitcnt vmcnt(6) lgkmcnt(6)
    v_mfma_f32_32x32x16_bf16 v[128:143], a[0:3], v[32:35], v[128:143]
    s_waitcnt lgkmcnt(4)
    v_mfma_f32_32x32x16_bf16 v[144:159], a[4:7], v[32:35], v[144:159]
    buffer_load_dwordx4 v[20:23], v3, s[28:31], s48 offen offset:1024 sc1
    s_waitcnt vmcnt(5)
    s_barrier
    ds_read_b64_tr_b16 a[16:17], v8 offset:4096
    ds_read_b64_tr_b16 a[18:19], v8 offset:5120
    ds_read_b64_tr_b16 a[20:21], v9 offset:4096
    ds_read_b64_tr_b16 a[22:23], v9 offset:5120
    s_waitcnt vmcnt(4) lgkmcnt(6)
    v_mfma_f32_32x32x16_bf16 v[128:143], a[8:11], v[36:39], v[128:143]
    s_lshl_b32 s10, s37, 13
    s_add_u32 s10, s10, s19
    s_lshl_b32 s17, s38, 12
    s_add_u32 s10, s10, s17
    s_mul_i32 s86, s37, 401408
    s_lshl_b32 s17, s82, 7
    s_add_u32 s86, s86, s17
    s_mul_i32 s17, s38, 28672
    s_add_u32 s86, s86, s17
    s_add_u32 s87, s83, 5
    s_cmp_ge_u32 s87, 7
    s_cselect_b32 s17, 7, 0
    s_sub_u32 s87, s87, s17
    s_mul_i32 s87, s87, 57344
    s_add_u32 s86, s86, s87
    s_add_u32 m0, s10, 0
    s_nop 0
    buffer_load_dwordx4 v5, s[32:35], s86 offen lds
    s_add_u32 m0, s10, 1024
    s_add_u32 s86, s86, 7168
    buffer_load_dwordx4 v5, s[32:35], s86 offen lds
    s_waitcnt lgkmcnt(4)
    v_mfma_f32_32x32x16_bf16 v[144:159], a[12:15], v[36:39], v[144:159]
    buffer_load_dwordx2 v[96:97], v94, s[28:31], 0 offen sc1
    ds_read_b64_tr_b16 a[0:1], v8 offset:6144
    ds_read_b64_tr_b16 a[2:3], v8 offset:7168
    ds_read_b64_tr_b16 a[4:5], v9 offset:6144
    ds_read_b64_tr_b16 a[6:7], v9 offset:7168
    s_waitcnt vmcnt(6) lgkmcnt(6)
    v_mfma_f32_32x32x16_bf16 v[128:143], a[16:19], v[40:43], v[128:143]
    s_add_u32 m0, s10, 2048
    s_add_u32 s86, s86, 7168
    buffer_load_dwordx4 v5, s[32:35], s86 offen lds
    s_add_u32 m0, s10, 3072
    s_add_u32 s86, s86, 7168
    buffer_load_dwordx4 v5, s[32:35], s86 offen lds
    s_waitcnt lgkmcnt(4)
    v_mfma_f32_32x32x16_bf16 v[144:159], a[20:23], v[40:43], v[144:159]
    buffer_load_dwordx4 v[24:27], v3, s[28:31], s48 offen offset:2048 sc1
    s_lshl_b32 s11, s37, 3
    s_lshr_b32 s11, 117835012, s11
    s_and_b32 s11, s11, 31
    s_lshl_b32 s11, s11, 13
    v_add_u32 v8, s11, v6
    v_add_u32 v9, s11, v7
    ds_read_b64_tr_b16 a[8:9], v8 offset:0
    ds_read_b64_tr_b16 a[10:11], v8 offset:1024
    ds_read_b64_tr_b16 a[12:13], v9 offset:0
    ds_read_b64_tr_b16 a[14:15], v9 offset:1024
    s_waitcnt vmcnt(8) lgkmcnt(6)
    v_mfma_f32_32x32x16_bf16 v[128:143], a[0:3], v[44:47], v[128:143]
    s_lshl_b32 s10, s37, 3
    s_lshr_b32 s10, 235736067, s10
    s_and_b32 s10, s10, 31
    s_lshl_b32 s10, s10, 13
    s_lshl_b32 s17, s38, 12
    s_add_u32 s10, s10, s17
    s_mul_i32 s86, s37, 100352
    s_lshl_b32 s17, s82, 7
    s_add_u32 s86, s86, s17
    s_mul_i32 s17, s38, 21504
    s_add_u32 s86, s86, s17
    s_mov_b32 s87, 57344
    s_lshl_b32 s17, s38, 10
    s_sub_u32 s10, s10, s17
    s_add_u32 s86, s86, s87
    s_add_u32 m0, s10, 0
    s_nop 0
    buffer_load_dwordx4 v5, s[88:91], s86 offen lds
    s_add_u32 m0, s10, 1024
    s_add_u32 s86, s86, 7168
    buffer_load_dwordx4 v5, s[88:91], s86 offen lds
    s_waitcnt lgkmcnt(4)
    v_mfma_f32_32x32x16_bf16 v[144:159], a[4:7], v[44:47], v[144:159]
    buffer_load_dwordx4 v[28:31], v3, s[28:31], s48 offen offset:3072 sc1
    s_add_u32 s48, s48, 4096
    s_cmp_eq_u32 s48, 28672
    s_cselect_b32 s48, 0, s48
    ds_read_b64_tr_b16 a[16:17], v8 offset:2048
    ds_read_b64_tr_b16 a[18:19], v8 offset:3072
    ds_read_b64_tr_b16 a[20:21], v9 offset:2048
    ds_read_b64_tr_b16 a[22:23], v9 offset:3072
    s_waitcnt vmcnt(10) lgkmcnt(6)
    v_mfma_f32_32x32x16_bf16 v[128:143], a[8:11], v[16:19], v[128:143]
    s_add_u32 m0, s10, 2048
    s_add_u32 s86, s86, 7168
    buffer_load_dwordx4 v5, s[88:91], s86 offen lds
    s_waitcnt lgkmcnt(4)
    v_mfma_f32_32x32x16_bf16 v[144:159], a[12:15], v[16:19], v[144:159]
    buffer_load_dwordx4 v[32:35], v3, s[28:31], s48 offen offset:0 sc1
    ds_read_b64_tr_b16 a[0:1], v8 offset:4096
    ds_read_b64_tr_b16 a[2:3], v8 offset:5120
    ds_read_b64_tr_b16 a[4:5], v9 offset:4096
    ds_read_b64_tr_b16 a[6:7], v9 offset:5120
    s_waitcnt vmcnt(11) lgkmcnt(6)
    v_mfma_f32_32x32x16_bf16 v[128:143], a[16:19], v[20:23], v[128:143]
    s_waitcnt lgkmcnt(4)
    v_mfma_f32_32x32x16_bf16 v[144:159], a[20:23], v[20:23], v[144:159]
    s_waitcnt vmcnt(8)
    v_cmp_ne_u64 vcc, s[56:57], v[96:97]
    s_nop 4
    s_and_b64 vcc, vcc, s[58:59]
    s_cmp_eq_u64 vcc, 0
    s_cbranch_scc1 L_fo_ok
    s_mov_b32 s80, 0
L_fo_spin:
    s_add_u32 s80, s80, 1
    s_cmp_gt_u32 s80, 1048576
    s_cbranch_scc1 L_end
    s_sleep 4
    buffer_load_dwordx2 v[96:97], v94, s[28:31], 0 offen sc1
    s_waitcnt vmcnt(0)
    v_cmp_ne_u64 vcc, s[56:57], v[96:97]
    s_nop 4
    s_and_b64 vcc, vcc, s[58:59]
    s_cmp_eq_u64 vcc, 0
    s_cbranch_scc0 L_fo_spin
L_fo_ok:
    s_cmp_eq_u32 s79, 1
    s_cbranch_scc1 L_noinv_fo
    buffer_inv sc1
    s_waitcnt vmcnt(0)
L_noinv_fo:
    ds_read_b64_tr_b16 a[8:9], v8 offset:6144
    ds_read_b64_tr_b16 a[10:11], v8 offset:7168
    ds_read_b64_tr_b16 a[12:13], v9 offset:6144
    ds_read_b64_tr_b16 a[14:15], v9 offset:7168
    s_waitcnt vmcnt(5) lgkmcnt(6)
    v_mfma_f32_32x32x16_bf16 v[128:143], a[0:3], v[24:27], v[128:143]
    s_waitcnt lgkmcnt(4)
    v_mfma_f32_32x32x16_bf16 v[144:159], a[4:7], v[24:27], v[144:159]
    buffer_load_dwordx4 v[100:103], v3, s[28:31], s50 offen offset:0 sc1
    buffer_load_dwordx4 v[36:39], v3, s[28:31], s48 offen offset:1024 sc1
    s_barrier
    s_lshl_b32 s11, s37, 13
    s_add_u32 s11, s11, s19
    v_add_u32 v8, s11, v6
    v_add_u32 v9, s11, v7
    ds_read_b64_tr_b16 a[16:17], v8 offset:0
    ds_read_b64_tr_b16 a[18:19], v8 offset:1024
    ds_read_b64_tr_b16 a[20:21], v9 offset:0
    ds_read_b64_tr_b16 a[22:23], v9 offset:1024
    s_waitcnt vmcnt(4) lgkmcnt(6)
    v_mfma_f32_32x32x16_bf16 v[128:143], a[8:11], v[28:31], v[128:143]
    s_lshl_b32 s10, s37, 3
    s_lshr_b32 s10, 131347, s10
    s_and_b32 s10, s10, 31
    s_lshl_b32 s10, s10, 13
    s_lshl_b32 s17, s38, 12
    s_add_u32 s10, s10, s17
    s_mul_i32 s86, s37, 401408
    s_lshl_b32 s17, s82, 7
    s_add_u32 s86, s86, s17
    s_mul_i32 s17, s38, 28672
    s_add_u32 s86, s86, s17
    s_add_u32 s87, s83, 6
    s_cmp_ge_u32 s87, 7
    s_cselect_b32 s17, 7, 0
    s_sub_u32 s87, s87, s17
    s_mul_i32 s87, s87, 57344
    s_add_u32 s86, s86, s87
    s_add_u32 m0, s10, 0
    s_nop 0
    buffer_load_dwordx4 v5, s[32:35], s86 offen lds
    s_add_u32 m0, s10, 1024
    s_add_u32 s86, s86, 7168
    buffer_load_dwordx4 v5, s[32:35], s86 offen lds
    s_waitcnt lgkmcnt(4)
    v_mfma_f32_32x32x16_bf16 v[144:159], a[12:15], v[28:31], v[144:159]
    buffer_load_dwordx4 v[104:107], v3, s[28:31], s50 offen offset:1024 sc1
    ds_read_b64_tr_b16 a[0:1], v8 offset:2048
    ds_read_b64_tr_b16 a[2:3], v8 offset:3072
    ds_read_b64_tr_b16 a[4:5], v9 offset:2048
    ds_read_b64_tr_b16 a[6:7], v9 offset:3072
    s_waitcnt vmcnt(5) lgkmcnt(6)
    v_mfma_f32_32x32x16_bf16 v[128:143], a[16:19], v[32:35], v[128:143]
    s_add_u32 m0, s10, 2048
    s_add_u32 s86, s86, 7168
    buffer_load_dwordx4 v5, s[32:35], s86 offen lds
    s_add_u32 m0, s10, 3072
    s_add_u32 s86, s86, 7168
    buffer_load_dwordx4 v5, s[32:35], s86 offen lds
    s_waitcnt lgkmcnt(4)
    v_mfma_f32_32x32x16_bf16 v[144:159], a[20:23], v[32:35], v[144:159]
    buffer_load_dwordx4 v[40:43], v3, s[28:31], s48 offen offset:2048 sc1
    ds_read_b64_tr_b16 a[8:9], v8 offset:4096
    ds_read_b64_tr_b16 a[10:11], v8 offset:5120
    ds_read_b64_tr_b16 a[12:13], v9 offset:4096
    ds_read_b64_tr_b16 a[14:15], v9 offset:5120
    s_waitcnt vmcnt(6) lgkmcnt(6)
    v_mfma_f32_32x32x16_bf16 v[128:143], a[0:3], v[36:39], v[128:143]
    s_waitcnt lgkmcnt(4)
    v_mfma_f32_32x32x16_bf16 v[144:159], a[4:7], v[36:39], v[144:159]
    buffer_load_dwordx4 v[108:111], v3, s[28:31], s50 offen offset:2048 sc1
    buffer_load_dwordx4 v[44:47], v3, s[28:31], s48 offen offset:3072 sc1
    s_add_u32 s48, s48, 4096
    s_cmp_eq_u32 s48, 28672
    s_cselect_b32 s48, 0, s48
    buffer_load_dwordx4 v[64:67], v4, s[20:23], s51 offen
    ds_read_b64_tr_b16 a[16:17], v8 offset:6144
    ds_read_b64_tr_b16 a[18:19], v8 offset:7168
    ds_read_b64_tr_b16 a[20:21], v9 offset:6144
    ds_read_b64_tr_b16 a[22:23], v9 offset:7168
    s_waitcnt vmcnt(3) lgkmcnt(6)
    v_mfma_f32_32x32x16_bf16 v[128:143], a[8:11], v[40:43], v[128:143]
    s_waitcnt lgkmcnt(4)
    v_mfma_f32_32x32x16_bf16 v[144:159], a[12:15], v[40:43], v[144:159]
    buffer_load_dwordx4 v[112:115], v3, s[28:31], s50 offen offset:3072 sc1
    s_add_u32 s50, s50, 4096
    buffer_load_dwordx4 v[16:19], v3, s[28:31], s48 offen offset:0 sc1
    s_barrier
    s_lshl_b32 s11, s37, 3
    s_lshr_b32 s11, 131347, s11
    s_and_b32 s11, s11, 31
    s_lshl_b32 s11, s11, 13
    v_add_u32 v8, s11, v6
    v_add_u32 v9, s11, v7
    ds_read_b64_tr_b16 a[0:1], v8 offset:0
    ds_read_b64_tr_b16 a[2:3], v8 offset:1024
    ds_read_b64_tr_b16 a[4:5], v9 offset:0
    ds_read_b64_tr_b16 a[6:7], v9 offset:1024
    s_waitcnt vmcnt(3) lgkmcnt(6)
    v_mfma_f32_32x32x16_bf16 v[128:143], a[16:19], v[44:47], v[128:143]
    s_waitcnt lgkmcnt(4)
    v_mfma_f32_32x32x16_bf16 v[144:159], a[20:23], v[44:47], v[144:159]
    buffer_load_dwordx4 v[116:119], v3, s[28:31], s50 offen offset:0 sc1
    buffer_load_dwordx4 v[20:23], v3, s[28:31], s48 offen offset:1024 sc1
    ds_read_b64_tr_b16 a[8:9], v8 offset:2048
    ds_read_b64_tr_b16 a[10:11], v8 offset:3072
    ds_read_b64_tr_b16 a[12:13], v9 offset:2048
    ds_read_b64_tr_b16 a[14:15], v9 offset:3072
    s_waitcnt vmcnt(2) lgkmcnt(6)
    v_mfma_f32_32x32x16_bf16 v[128:143], a[0:3], v[16:19], v[128:143]
    s_waitcnt lgkmcnt(4)
    v_mfma_f32_32x32x16_bf16 v[144:159], a[4:7], v[16:19], v[144:159]
    buffer_load_dwordx4 v[120:123], v3, s[28:31], s50 offen offset:1024 sc1
    buffer_load_dwordx4 v[24:27], v3, s[28:31], s48 offen offset:2048 sc1
    buffer_load_dwordx4 v[124:127], v3, s[28:31], s50 offen offset:2048 sc1
    ds_read_b64_tr_b16 a[16:17], v8 offset:4096
    ds_read_b64_tr_b16 a[18:19], v8 offset:5120
    ds_read_b64_tr_b16 a[20:21], v9 offset:4096
    ds_read_b64_tr_b16 a[22:23], v9 offset:5120
    s_waitcnt vmcnt(3) lgkmcnt(6)
    v_mfma_f32_32x32x16_bf16 v[128:143], a[8:11], v[20:23], v[128:143]
    s_waitcnt lgkmcnt(4)
    v_mfma_f32_32x32x16_bf16 v[144:159], a[12:15], v[20:23], v[144:159]
    buffer_load_dwordx4 v[28:31], v3, s[28:31], s48 offen offset:3072 sc1
    s_add_u32 s48, s48, 4096
    s_cmp_eq_u32 s48, 28672
    s_cselect_b32 s48, 0, s48
    ds_read_b64_tr_b16 a[0:1], v8 offset:6144
    ds_read_b64_tr_b16 a[2:3], v8 offset:7168
    ds_read_b64_tr_b16 a[4:5], v9 offset:6144
    ds_read_b64_tr_b16 a[6:7], v9 offset:7168
    s_waitcnt vmcnt(2) lgkmcnt(6)
    v_mfma_f32_32x32x16_bf16 v[128:143], a[16:19], v[24:27], v[128:143]
    s_waitcnt lgkmcnt(4)
    v_mfma_f32_32x32x16_bf16 v[144:159], a[20:23], v[24:27], v[144:159]
    s_barrier
    s_lshl_b32 s11, s37, 13
    s_add_u32 s11, s11, s18
    v_add_u32 v98, s11, v6
    v_add_u32 v99, s11, v7
    ds_read_b64_tr_b16 a[8:9], v98 offset:0
    ds_read_b64_tr_b16 a[10:11], v98 offset:1024
    ds_read_b64_tr_b16 a[12:13], v99 offset:0
    ds_read_b64_tr_b16 a[14:15], v99 offset:1024
    s_waitcnt vmcnt(0) lgkmcnt(6)
    v_mfma_f32_32x32x16_bf16 v[128:143], a[0:3], v[28:31], v[128:143]
    v_lshlrev_b32 v56, 16, v64
    v_and_b32 v57, 0xffff0000, v64
    v_lshlrev_b32 v58, 16, v65
    v_and_b32 v59, 0xffff0000, v65
    s_waitcnt lgkmcnt(4)
    v_mfma_f32_32x32x16_bf16 v[144:159], a[4:7], v[28:31], v[144:159]
    ds_read_b64_tr_b16 a[16:17], v98 offset:2048
    ds_read_b64_tr_b16 a[18:19], v98 offset:3072
    ds_read_b64_tr_b16 a[20:21], v99 offset:2048
    ds_read_b64_tr_b16 a[22:23], v99 offset:3072
    v_lshlrev_b32 v60, 16, v66
    v_and_b32 v61, 0xffff0000, v66
    v_lshlrev_b32 v62, 16, v67
    v_and_b32 v63, 0xffff0000, v67
    s_waitcnt lgkmcnt(6)
    v_mfma_f32_32x32x16_bf16 v[160:175], a[8:11], v[100:103], 0
    ds_write_b128 v10, v[128:131] offset:0
    ds_write_b128 v11, v[132:135] offset:0
    s_waitcnt lgkmcnt(6)
    v_mfma_f32_32x32x16_bf16 v[176:191], a[12:15], v[100:103], 0
    ds_read_b64_tr_b16 a[0:1], v98 offset:4096
    ds_read_b64_tr_b16 a[2:3], v98 offset:5120
    ds_read_b64_tr_b16 a[4:5], v99 offset:4096
    ds_read_b64_tr_b16 a[6:7], v99 offset:5120
    ds_write_b128 v12, v[136:139] offset:0
    ds_write_b128 v13, v[140:143] offset:0
    s_waitcnt lgkmcnt(10)
    v_mfma_f32_32x32x16_bf16 v[160:175], a[16:19], v[104:107], v[160:175]
    ds_write_b128 v10, v[144:147] offset:128
    ds_write_b128 v11, v[148:151] offset:128
    s_waitcnt lgkmcnt(10)
    v_mfma_f32_32x32x16_bf16 v[176:191], a[20:23], v[104:107], v[176:191]
    ds_read_b64_tr_b16 a[8:9], v98 offset:6144
    ds_read_b64_tr_b16 a[10:11], v98 offset:7168
    ds_read_b64_tr_b16 a[12:13], v99 offset:6144
    ds_read_b64_tr_b16 a[14:15], v99 offset:7168
    ds_write_b128 v12, v[152:155] offset:128
    ds_write_b128 v13, v[156:159] offset:128
    s_waitcnt lgkmcnt(12)
    v_mfma_f32_32x32x16_bf16 v[160:175], a[0:3], v[108:111], v[160:175]
    s_waitcnt lgkmcnt(10)
    v_mfma_f32_32x32x16_bf16 v[176:191], a[4:7], v[108:111], v[176:191]
    s_waitcnt lgkmcnt(0)
    s_barrier
    s_lshl_b32 s11, s37, 3
    s_lshr_b32 s11, 235736067, s11
    s_and_b32 s11, s11, 31
    s_lshl_b32 s11, s11, 13
    v_add_u32 v98, s11, v6
    v_add_u32 v99, s11, v7
    ds_read_b64_tr_b16 a[16:17], v98 offset:0
    ds_read_b64_tr_b16 a[18:19], v98 offset:1024
    ds_read_b64_tr_b16 a[20:21], v99 offset:0
    ds_read_b64_tr_b16 a[22:23], v99 offset:1024
    v_mfma_f32_32x32x16_bf16 v[160:175], a[8:11], v[112:115], v[160:175]
    ds_read_b128 v[192:195], v14 offset:0
    ds_read_b128 v[196:199], v15 offset:0
    ds_read_b128 v[68:71], v14 offset:8192
    ds_read_b128 v[72:75], v15 offset:8192
    v_mfma_f32_32x32x16_bf16 v[176:191], a[12:15], v[112:115], v[176:191]
    ds_read_b64_tr_b16 a[0:1], v98 offset:2048
    ds_read_b64_tr_b16 a[2:3], v98 offset:3072
    ds_read_b64_tr_b16 a[4:5], v99 offset:2048
    ds_read_b64_tr_b16 a[6:7], v99 offset:3072
    ds_read_b128 v[76:79], v14 offset:16384
    ds_read_b128 v[80:83], v15 offset:16384
    ds_read_b128 v[84:87], v14 offset:24576
    ds_read_b128 v[88:91], v15 offset:24576
    s_waitcnt lgkmcnt(14)
    v_mfma_f32_32x32x16_bf16 v[160:175], a[16:19], v[116:119], v[160:175]
    s_waitcnt lgkmcnt(9)
    v_add_f32 v192, v192, v68
    s_waitcnt lgkmcnt(1)
    v_add_f32 v76, v76, v84
    v_add_f32 v193, v193, v69
    v_add_f32 v77, v77, v85
    v_add_f32 v194, v194, v70
    v_add_f32 v78, v78, v86
    v_add_f32 v195, v195, v71
    v_add_f32 v79, v79, v87
    v_add_f32 v196, v196, v72
    s_waitcnt lgkmcnt(0)
    v_add_f32 v80, v80, v88
    v_mfma_f32_32x32x16_bf16 v[176:191], a[20:23], v[116:119], v[176:191]
    ds_read_b64_tr_b16 a[8:9], v98 offset:4096
    ds_read_b64_tr_b16 a[10:11], v98 offset:5120
    ds_read_b64_tr_b16 a[12:13], v99 offset:4096
    ds_read_b64_tr_b16 a[14:15], v99 offset:5120
    v_add_f32 v197, v197, v73
    v_add_f32 v81, v81, v89
    v_add_f32 v198, v198, v74
    v_add_f32 v82, v82, v90
    v_add_f32 v199, v199, v75
    v_add_f32 v83, v83, v91
    v_add_f32 v192, v192, v76
    v_add_f32 v193, v193, v77
    v_add_f32 v194, v194, v78
    v_add_f32 v195, v195, v79
    v_add_f32 v196, v196, v80
    v_mfma_f32_32x32x16_bf16 v[160:175], a[0:3], v[120:123], v[160:175]
    v_add_f32 v197, v197, v81
    v_add_f32 v198, v198, v82
    v_add_f32 v199, v199, v83
    v_exp_f32 v200, v192
    v_exp_f32 v201, v193
    v_exp_f32 v202, v194
    v_exp_f32 v203, v195
    v_exp_f32 v204, v196
    v_exp_f32 v205, v197
    v_exp_f32 v206, v198
    v_mfma_f32_32x32x16_bf16 v[176:191], a[4:7], v[120:123], v[176:191]
    v_exp_f32 v207, v199
    v_add_f32 v200, 1.0, v200
    v_add_f32 v201, 1.0, v201
    v_add_f32 v202, 1.0, v202
    v_add_f32 v203, 1.0, v203
    v_add_f32 v204, 1.0, v204
    v_add_f32 v205, 1.0, v205
    v_add_f32 v206, 1.0, v206
    v_add_f32 v207, 1.0, v207
    v_rcp_f32 v200, v200
    v_rcp_f32 v201, v201
    s_barrier
    s_waitcnt lgkmcnt(2)
    v_mfma_f32_32x32x16_bf16 v[160:175], a[8:11], v[124:127], v[160:175]
    v_rcp_f32 v202, v202
    v_rcp_f32 v203, v203
    v_rcp_f32 v204, v204
    v_rcp_f32 v205, v205
    v_rcp_f32 v206, v206
    v_rcp_f32 v207, v207
    v_mul_f32 v192, s54, v192
    v_mul_f32 v193, s54, v193
    v_mul_f32 v194, s54, v194
    v_mul_f32 v195, s54, v195
    v_mul_f32 v196, s54, v196
    s_waitcnt lgkmcnt(0)
    v_mfma_f32_32x32x16_bf16 v[176:191], a[12:15], v[124:127], v[176:191]
    v_mul_f32 v197, s54, v197
    v_mul_f32 v198, s54, v198
    v_mul_f32 v199, s54, v199
    v_mul_f32 v192, v192, v200
    v_mul_f32 v193, v193, v201
    v_mul_f32 v194, v194, v202
    v_mul_f32 v195, v195, v203
    v_mul_f32 v196, v196, v204
    v_mul_f32 v197, v197, v205
    v_mul_f32 v198, v198, v206
    v_mul_f32 v199, v199, v207
    ds_write_b128 v10, v[160:163] offset:0
    ds_write_b128 v11, v[164:167] offset:0
    ds_write_b128 v12, v[168:171] offset:0
    ds_write_b128 v13, v[172:175] offset:0
    ds_write_b128 v10, v[176:179] offset:128
    ds_write_b128 v11, v[180:183] offset:128
    ds_write_b128 v12, v[184:187] offset:128
    ds_write_b128 v13, v[188:191] offset:128
    s_waitcnt lgkmcnt(0)
    s_barrier
    ds_read_b128 v[48:51], v14 offset:0
    ds_read_b128 v[52:55], v15 offset:0
    ds_read_b128 v[68:71], v14 offset:8192
    ds_read_b128 v[72:75], v15 offset:8192
    ds_read_b128 v[76:79], v14 offset:16384
    ds_read_b128 v[80:83], v15 offset:16384
    ds_read_b128 v[84:87], v14 offset:24576
    ds_read_b128 v[88:91], v15 offset:24576
    s_waitcnt lgkmcnt(5)
    v_pk_add_f32 v[48:49], v[48:49], v[68:69]
    v_pk_add_f32 v[50:51], v[50:51], v[70:71]
    s_waitcnt lgkmcnt(4)
    v_pk_add_f32 v[52:53], v[52:53], v[72:73]
    v_pk_add_f32 v[54:55], v[54:55], v[74:75]
    s_waitcnt lgkmcnt(1)
    v_pk_add_f32 v[76:77], v[76:77], v[84:85]
    v_pk_add_f32 v[78:79], v[78:79], v[86:87]
    s_waitcnt lgkmcnt(0)
    v_pk_add_f32 v[80:81], v[80:81], v[88:89]
    v_pk_add_f32 v[82:83], v[82:83], v[90:91]
    v_pk_add_f32 v[48:49], v[48:49], v[76:77]
    v_pk_add_f32 v[50:51], v[50:51], v[78:79]
    v_pk_add_f32 v[52:53], v[52:53], v[80:81]
    v_pk_add_f32 v[54:55], v[54:55], v[82:83]
    v_pk_fma_f32 v[48:49], v[48:49], v[192:193], v[56:57]
    v_pk_fma_f32 v[50:51], v[50:51], v[194:195], v[58:59]
    v_pk_fma_f32 v[52:53], v[52:53], v[196:197], v[60:61]
    v_pk_fma_f32 v[54:55], v[54:55], v[198:199], v[62:63]
    v_cvt_pk_bf16_f32 v64, v48, v49
    v_cvt_pk_bf16_f32 v65, v50, v51
    v_cvt_pk_bf16_f32 v66, v52, v53
    v_cvt_pk_bf16_f32 v67, v54, v55
    buffer_store_dwordx4 v[64:67], v4, s[24:27], s51 offen
    s_endpgm
L_qkv:
    s_mov_b32 s16, 1204224
    s_add_u32 s24, s6, s62
    s_addc_u32 s25, s7, 0
    s_sub_u32 s26, s16, s62
    s_mov_b32 s27, 0x20000
    s_add_u32 m0, s51, 8192
    s_nop 0
    buffer_load_dwordx4 v3, s[24:27], s66 offen lds
    s_add_u32 m0, s50, 65536
    s_add_u32 s48, s48, 128
    s_cmp_eq_u32 s48, s49
    s_cselect_b32 s42, 896, 0
    s_sub_u32 s48, s48, s42
    buffer_load_dwordx4 v6, s[20:23], s48 offen lds
    s_add_u32 m0, s50, 66560
    s_add_u32 s42, s48, 7168
    buffer_load_dwordx4 v7, s[20:23], s42 offen lds
    s_add_u32 m0, s51, 16384
    s_nop 0
    buffer_load_dwordx4 v3, s[24:27], s67 offen lds
    s_mov_b32 s92, s98
    s_mov_b32 s93, s99
    s_mov_b32 s94, 256
    s_mov_b32 s95, 0x20000
    s_memrealtime s[56:57]
    s_cmp_eq_u32 s2, 0
    s_cselect_b32 s42, 0, 1
    s_add_u32 s42, s42, s36
    s_lshl_b32 s42, s42, 8
    v_mov_b32 v226, 0
    s_waitcnt lgkmcnt(0)
    s_or_b32 s56, s56, 1
    v_mov_b32 v224, s56
    v_mov_b32 v225, s57
    s_mov_b64 exec, 1
    buffer_store_dwordx2 v[224:225], v226, s[92:95], s42 offen sc1
    s_mov_b64 exec, -1
    s_add_u32 s68, s84, 128
    s_cmp_ge_u32 s68, 448
    s_cselect_b32 s43, 448, 0
    s_sub_u32 s68, s68, s43
    s_mul_i32 s68, s68, 2688
    s_add_u32 s69, s84, 192
    s_cmp_ge_u32 s69, 448
    s_cselect_b32 s43, 448, 0
    s_sub_u32 s69, s69, s43
    s_mul_i32 s69, s69, 2688
    s_add_u32 s70, s84, 256
    s_cmp_ge_u32 s70, 448
    s_cselect_b32 s43, 448, 0
    s_sub_u32 s70, s70, s43
    s_mul_i32 s70, s70, 2688
    s_add_u32 s71, s84, 320
    s_cmp_ge_u32 s71, 448
    s_cselect_b32 s43, 448, 0
    s_sub_u32 s71, s71, s43
    s_mul_i32 s71, s71, 2688
    s_add_u32 s72, s84, 384
    s_cmp_ge_u32 s72, 448
    s_cselect_b32 s43, 448, 0
    s_sub_u32 s72, s72, s43
    s_mul_i32 s72, s72, 2688
    s_add_u32 s63, s62, 896
    s_lshl_b32 s64, s40, 7
    s_cmp_eq_u32 s40, 7
    s_cselect_b32 s64, s16, s64
    v_lshrrev_b32 v224, 3, v1
    v_mul_u32_u24 v4, 2688, v224
    v_lshlrev_b32 v224, 1, v224
    v_and_b32 v224, 4, v224
    v_and_b32 v225, 7, v1
    v_xor_b32 v224, v224, v225
    v_lshl_add_u32 v4, v224, 4, v4
    s_lshl_b32 s42, s40, 12
    s_mul_i32 s4, s73, 143360
    s_add_u32 s4, s4, s42
    s_lshl_b32 s42, s38, 11
    s_add_u32 s4, s4, s42
    s_add_u32 s4, s4, 114688
    s_lshl_b32 s75, s39, 3
    s_add_u32 s75, s75, s40
    s_lshl_b32 s75, s75, 3
    s_add_u32 s75, s75, s36
    s_lshl_b32 s75, s75, 10
    s_add_u32 s75, s75, 11534336
    s_mov_b32 s74, 1060205080
    s_mul_i32 s84, s38, 48
    v_lshrrev_b32 v224, 5, v1
    v_mul_u32_u24 v8, 1024, v224
    v_bfe_u32 v224, v1, 2, 2
    v_lshl_add_u32 v8, v224, 7, v8
    v_lshrrev_b32 v224, 1, v224
    v_lshlrev_b32 v224, 6, v224
    v_bfe_u32 v225, v1, 4, 1
    v_lshlrev_b32 v225, 5, v225
    v_and_b32 v226, 3, v1
    v_lshl_add_u32 v225, v226, 3, v225
    v_add_u32 v225, s84, v225
    v_xor_b32 v224, v224, v225
    v_add_u32 v8, v8, v224
    s_lshl_b32 s43, s38, 1
    s_xor_b32 s43, s43, s37
    s_lshl_b32 s43, s43, 11
    v_add_u32 v8, s43, v8
    v_xor_b32 v9, 2048, v8
    v_add_u32 v9, 8192, v9
    v_xor_b32 v10, 4096, v8
    v_add_u32 v10, 8192, v10
    v_xor_b32 v11, 6144, v8
    v_add_u32 v11, 8192, v11
    v_add_u32 v8, 8192, v8
    s_mul_i32 s42, s38, 28
    s_sub_u32 s42, 28, s42
    v_and_b32 v224, 31, v1
    v_cmp_eq_u32 s[54:55], s42, v224
    s_mov_b32 s28, s18
    s_mov_b32 s29, s19
    s_mov_b32 s30, 14680064
    s_mov_b32 s31, 0x20000
    s_mov_b32 s44, 0x3f803f80
    s_lshl_b32 s42, s38, 1
    s_xor_b32 s42, s42, s37
    s_lshl_b32 s84, s42, 11
    s_lshl_b32 s42, s42, 5
    s_lshl_b32 s43, s37, 12
    s_add_u32 s43, s43, 49152
    v_and_b32 v224, 31, v1
    v_lshlrev_b32 v176, 7, v224
    v_lshlrev_b32 v172, 4, v224
    v_lshrrev_b32 v224, 1, v224
    v_and_b32 v224, 7, v224
    v_lshrrev_b32 v225, 5, v1
    v_xor_b32 v224, v224, v225
    v_lshl_add_u32 v176, v224, 4, v176
    v_xor_b32 v176, s42, v176
    v_add_u32 v176, s43, v176
    v_xor_b32 v177, 32, v176
    v_xor_b32 v178, 64, v176
    v_xor_b32 v179, 96, v176
    v_lshlrev_b32 v2, 4, v1
    s_lshl_b32 s42, s38, 9
    s_add_u32 s42, s42, 3072
    v_add_u32 v172, s42, v172
    s_lshl_b32 s42, s37, 2
    v_add_u32 v171, s42, v172
    v_mov_b32 v170, 0x358637bd
    v_and_b32 v224, 15, v1
    v_bfe_u32 v225, v1, 4, 1
    v_lshlrev_b32 v225, 2, v225
    v_and_b32 v224, 7, v224
    v_cmp_eq_u32 vcc, v224, v225
    v_mov_b32 v226, s44
    s_nop 0
    v_cndmask_b32 v164, 0, v226, vcc
    v_mov_b32 v165, v164
    v_mov_b32 v166, v164
    v_mov_b32 v167, v164
    v_mov_b32 v184, 0
    v_mov_b32 v185, 0
    v_mov_b32 v186, 0
    v_mov_b32 v187, 0
    s_waitcnt vmcnt(4)
    s_barrier
    ds_read_b128 v[16:19], v176 offset:0
    ds_read_b128 v[20:23], v177 offset:0
    ds_read_b64_tr_b16 a[0:1], v8 offset:0
    ds_read_b64_tr_b16 a[2:3], v8 offset:512
    ds_read_b64_tr_b16 a[4:5], v9 offset:0
    ds_read_b64_tr_b16 a[6:7], v9 offset:512
    ds_read_b64_tr_b16 a[8:9], v10 offset:0
    ds_read_b64_tr_b16 a[10:11], v10 offset:512
    ds_read_b128 v[24:27], v178 offset:0
    ds_read_b128 v[28:31], v179 offset:0
    s_add_u32 m0, s50, 81920
    s_add_u32 s48, s48, 128
    s_cmp_eq_u32 s48, s49
    s_cselect_b32 s42, 896, 0
    s_sub_u32 s48, s48, s42
    buffer_load_dwordx4 v6, s[20:23], s48 offen lds
    s_add_u32 m0, s50, 82944
    s_add_u32 s42, s48, 7168
    buffer_load_dwordx4 v7, s[20:23], s42 offen lds
    s_add_u32 m0, s51, 24576
    s_nop 0
    buffer_load_dwordx4 v3, s[24:27], s68 offen lds
    s_waitcnt lgkmcnt(6)
    v_mfma_f32_32x32x16_bf16 v[128:143], v[16:19], a[0:3], 0
    v_mfma_f32_16x16x32_bf16 v[160:163], v[164:167], a[0:3], 0
    s_waitcnt vmcnt(4)
    s_barrier
    ds_read_b128 v[32:35], v176 offset:16384
    ds_read_b128 v[36:39], v177 offset:16384
    s_lshl_b32 s76, s73, 8
    s_add_u32 s76, s76, 13107200
    s_lshl_b32 s42, s46, 1
    s_add_u32 s42, s42, s38
    s_lshl_b32 s42, s42, 3
    s_add_u32 s76, s76, s42
    s_mul_i32 s73, s73, 143360
    s_and_b32 s42, s2, 7
    s_lshl_b32 s42, s42, 2
    s_add_u32 s42, s42, s41
    s_sub_u32 s42, s42, 14
    s_and_b32 s78, s41, 1
    s_add_u32 s42, s42, s78
    s_add_u32 s42, s42, s38
    s_lshl_b32 s78, s42, 7
    s_add_u32 s78, s78, 13205504
    s_sub_u32 s43, s41, 12
    s_lshr_b32 s43, s43, 2
    s_getreg_b32 s79, hwreg(HW_REG_XCC_ID, 0, 4)
    s_cmp_lt_u32 s41, 12
    s_cselect_b32 s42, 0, 4
    s_sub_u32 s42, s41, s42
    s_lshr_b32 s82, s42, 2
    s_and_b32 s42, s42, 3
    s_and_b32 s81, s2, 7
    s_lshl_b32 s81, s81, 2
    s_add_u32 s81, s81, s42
    s_min_u32 s83, s82, 6
    s_mov_b32 s32, s14
    s_mov_b32 s33, s15
    s_mov_b32 s100, s14
    s_mov_b32 s101, s15
    s_mov_b32 s35, 0x20000
    s_mov_b32 s88, s8
    s_mov_b32 s89, s9
    s_mov_b32 s91, 0x20000
    s_cmp_eq_u32 s43, 0
    s_cselect_b32 s34, 0, 1605632
    s_cselect_b32 s90, 0, 401408
    v_lshrrev_b32 v224, 3, v1
    v_mul_u32_u24 v5, 896, v224
    v_lshlrev_b32 v224, 1, v224
    v_and_b32 v224, 4, v224
    v_and_b32 v225, 7, v1
    v_xor_b32 v224, v224, v225
    v_lshl_add_u32 v5, v224, 4, v5
    s_mov_b32 s18, 65536
    s_mov_b32 s19, 122880
    s_sub_u32 s77, s78, 13205504
    s_lshl_b32 s77, s77, 3
    s_add_u32 s77, s77, 12582912
    s_xor_b32 s42, s40, 7
    s_add_u32 s42, s42, s37
    s_cmp_eq_u32 s42, 0
    s_cselect_b32 s77, s77, 14680064
    ds_read_b64_tr_b16 a[12:13], v11 offset:0
    ds_read_b64_tr_b16 a[14:15], v11 offset:512
    s_waitcnt lgkmcnt(8)
    v_mfma_f32_32x32x16_bf16 v[128:143], v[20:23], a[4:7], v[128:143]
    ds_read_b128 v[40:43], v178 offset:16384
    s_add_u32 m0, s50, 98304
    s_add_u32 s48, s48, 128
    s_cmp_eq_u32 s48, s49
    s_cselect_b32 s42, 896, 0
    s_sub_u32 s48, s48, s42
    buffer_load_dwordx4 v6, s[20:23], s48 offen lds
    ds_read_b64_tr_b16 a[16:17], v8 offset:8192
    ds_read_b64_tr_b16 a[18:19], v8 offset:8704
    s_waitcnt lgkmcnt(8)
    v_mfma_f32_32x32x16_bf16 v[128:143], v[24:27], a[8:11], v[128:143]
    ds_read_b128 v[44:47], v179 offset:16384
    s_add_u32 m0, s50, 99328
    s_add_u32 s42, s48, 7168
    buffer_load_dwordx4 v7, s[20:23], s42 offen lds
    v_dot2c_f32_bf16 v186, v16, v16
    v_dot2c_f32_bf16 v187, v17, v17
    v_dot2c_f32_bf16 v186, v18, v18
    v_dot2c_f32_bf16 v187, v19, v19
    v_dot2c_f32_bf16 v186, v20, v20
    v_dot2c_f32_bf16 v187, v21, v21
    v_dot2c_f32_bf16 v186, v22, v22
    v_dot2c_f32_bf16 v187, v23, v23
    v_mfma_f32_16x16x32_bf16 v[192:195], v[164:167], v[16:19], 0
    v_mfma_f32_16x16x32_bf16 v[192:195], v[164:167], v[20:23], v[192:195]
    ds_read_b64_tr_b16 a[0:1], v9 offset:8192
    ds_read_b64_tr_b16 a[2:3], v9 offset:8704
    s_waitcnt lgkmcnt(6)
    v_mfma_f32_32x32x16_bf16 v[128:143], v[28:31], a[12:15], v[128:143]
    s_add_u32 m0, s51, 32768
    s_nop 0
    buffer_load_dwordx4 v3, s[24:27], s69 offen lds
    ds_read_b64_tr_b16 a[4:5], v10 offset:8192
    ds_read_b64_tr_b16 a[6:7], v10 offset:8704
    s_waitcnt lgkmcnt(5)
    v_mfma_f32_32x32x16_bf16 v[128:143], v[32:35], a[16:19], v[128:143]
    v_mfma_f32_16x16x32_bf16 v[160:163], v[164:167], a[16:19], v[160:163]
    s_waitcnt vmcnt(3) lgkmcnt(4)
    s_barrier
    ds_read_b128 v[48:51], v176 offset:32768
    ds_read_b128 v[52:55], v177 offset:32768
    ds_read_b64_tr_b16 a[8:9], v11 offset:8192
    ds_read_b64_tr_b16 a[10:11], v11 offset:8704
    s_waitcnt lgkmcnt(6)
    v_mfma_f32_32x32x16_bf16 v[128:143], v[36:39], a[0:3], v[128:143]
    ds_read_b128 v[56:59], v178 offset:32768
    v_mov_b32 v200, -1
    v_mov_b32 v201, -1
    v_mov_b32 v202, -1
    v_mov_b32 v203, -1
    buffer_store_dwordx4 v[200:203], v2, s[28:31], s75 offen sc1
    buffer_store_dwordx4 v[200:203], v2, s[28:31], s77 offen sc1
    s_add_u32 m0, s50, 114688
    s_add_u32 s48, s48, 128
    s_cmp_eq_u32 s48, s49
    s_cselect_b32 s42, 896, 0
    s_sub_u32 s48, s48, s42
    buffer_load_dwordx4 v6, s[20:23], s48 offen lds
    ds_read_b64_tr_b16 a[12:13], v8 offset:16384
    ds_read_b64_tr_b16 a[14:15], v8 offset:16896
    s_waitcnt lgkmcnt(7)
    v_mfma_f32_32x32x16_bf16 v[128:143], v[40:43], a[4:7], v[128:143]
    ds_read_b128 v[60:63], v179 offset:32768
    s_add_u32 m0, s50, 115712
    s_add_u32 s42, s48, 7168
    buffer_load_dwordx4 v7, s[20:23], s42 offen lds
    v_dot2c_f32_bf16 v186, v32, v32
    v_dot2c_f32_bf16 v187, v33, v33
    v_dot2c_f32_bf16 v186, v34, v34
    v_dot2c_f32_bf16 v187, v35, v35
    v_dot2c_f32_bf16 v186, v36, v36
    v_dot2c_f32_bf16 v187, v37, v37
    v_dot2c_f32_bf16 v186, v38, v38
    v_dot2c_f32_bf16 v187, v39, v39
    v_mfma_f32_16x16x32_bf16 v[192:195], v[164:167], v[32:35], v[192:195]
    v_mfma_f32_16x16x32_bf16 v[192:195], v[164:167], v[36:39], v[192:195]
    ds_read_b64_tr_b16 a[16:17], v9 offset:16384
    ds_read_b64_tr_b16 a[18:19], v9 offset:16896
    s_waitcnt lgkmcnt(6)
    v_mfma_f32_32x32x16_bf16 v[128:143], v[44:47], a[8:11], v[128:143]
    s_add_u32 m0, s51, 40960
    s_nop 0
    buffer_load_dwordx4 v3, s[24:27], s70 offen lds
    ds_read_b64_tr_b16 a[0:1], v10 offset:16384
    ds_read_b64_tr_b16 a[2:3], v10 offset:16896
    s_waitcnt lgkmcnt(5)
    v_mfma_f32_32x32x16_bf16 v[128:143], v[48:51], a[12:15], v[128:143]
    v_mfma_f32_16x16x32_bf16 v[160:163], v[164:167], a[12:15], v[160:163]
    s_waitcnt vmcnt(5) lgkmcnt(4)
    s_barrier
    ds_read_b128 v[64:67], v176 offset:49152
    ds_read_b128 v[68:71], v177 offset:49152
    ds_read_b64_tr_b16 a[4:5], v11 offset:16384
    ds_read_b64_tr_b16 a[6:7], v11 offset:16896
    s_waitcnt lgkmcnt(6)
    v_mfma_f32_32x32x16_bf16 v[128:143], v[52:55], a[16:19], v[128:143]
    ds_read_b128 v[72:75], v178 offset:49152
    s_add_u32 m0, s50, 131072
    s_add_u32 s48, s48, 128
    s_cmp_eq_u32 s48, s49
    s_cselect_b32 s42, 896, 0
    s_sub_u32 s48, s48, s42
    buffer_load_dwordx4 v6, s[20:23], s48 offen lds
    v_mov_b32 v173, 0
    buffer_load_dwordx2 v[174:175], v173, s[92:95], 0 offen sc1
    ds_read_b64_tr_b16 a[8:9], v8 offset:24576
    ds_read_b64_tr_b16 a[10:11], v8 offset:25088
    s_waitcnt lgkmcnt(7)
    v_mfma_f32_32x32x16_bf16 v[128:143], v[56:59], a[0:3], v[128:143]
    ds_read_b128 v[76:79], v179 offset:49152
    s_add_u32 m0, s50, 132096
    s_add_u32 s42, s48, 7168
    buffer_load_dwordx4 v7, s[20:23], s42 offen lds
    v_dot2c_f32_bf16 v186, v48, v48
    v_dot2c_f32_bf16 v187, v49, v49
    v_dot2c_f32_bf16 v186, v50, v50
    v_dot2c_f32_bf16 v187, v51, v51
    v_dot2c_f32_bf16 v186, v52, v52
    v_dot2c_f32_bf16 v187, v53, v53
    v_dot2c_f32_bf16 v186, v54, v54
    v_dot2c_f32_bf16 v187, v55, v55
    v_mfma_f32_16x16x32_bf16 v[192:195], v[164:167], v[48:51], v[192:195]
    v_mfma_f32_16x16x32_bf16 v[192:195], v[164:167], v[52:55], v[192:195]
    ds_read_b64_tr_b16 a[12:13], v9 offset:24576
    ds_read_b64_tr_b16 a[14:15], v9 offset:25088
    s_waitcnt lgkmcnt(6)
    v_mfma_f32_32x32x16_bf16 v[128:143], v[60:63], a[4:7], v[128:143]
    s_add_u32 m0, s51, 49152
    s_nop 0
    buffer_load_dwordx4 v3, s[24:27], s71 offen lds
    ds_read_b64_tr_b16 a[16:17], v10 offset:24576
    ds_read_b64_tr_b16 a[18:19], v10 offset:25088
    s_waitcnt lgkmcnt(5)
    v_mfma_f32_32x32x16_bf16 v[128:143], v[64:67], a[8:11], v[128:143]
    v_mfma_f32_16x16x32_bf16 v[160:163], v[164:167], a[8:11], v[160:163]
    s_waitcnt vmcnt(4) lgkmcnt(4)
    s_barrier
    v_add_u32 v176, 65536, v176
    v_add_u32 v177, 65536, v177
    v_add_u32 v178, 65536, v178
    v_add_u32 v179, 65536, v179
    ds_read_b128 v[80:83], v176 offset:0
    ds_read_b128 v[84:87], v177 offset:0
    ds_read_b64_tr_b16 a[0:1], v11 offset:24576
    ds_read_b64_tr_b16 a[2:3], v11 offset:25088
    s_waitcnt lgkmcnt(6)
    v_mfma_f32_32x32x16_bf16 v[128:143], v[68:71], a[12:15], v[128:143]
    ds_read_b128 v[88:91], v178 offset:0
    s_add_u32 m0, s50, 147456
    s_add_u32 s48, s48, 128
    s_cmp_eq_u32 s48, s49
    s_cselect_b32 s42, 896, 0
    s_sub_u32 s48, s48, s42
    buffer_load_dwordx4 v6, s[20:23], s48 offen lds
    ds_read_b64_tr_b16 a[4:5], v8 offset:32768
    ds_read_b64_tr_b16 a[6:7], v8 offset:33280
    s_waitcnt lgkmcnt(7)
    v_mfma_f32_32x32x16_bf16 v[128:143], v[72:75], a[16:19], v[128:143]
    ds_read_b128 v[92:95], v179 offset:0
    s_add_u32 m0, s50, 148480
    s_add_u32 s42, s48, 7168
    buffer_load_dwordx4 v7, s[20:23], s42 offen lds
    v_dot2c_f32_bf16 v186, v64, v64
    v_dot2c_f32_bf16 v187, v65, v65
    v_dot2c_f32_bf16 v186, v66, v66
    v_dot2c_f32_bf16 v187, v67, v67
    v_dot2c_f32_bf16 v186, v68, v68
    v_dot2c_f32_bf16 v187, v69, v69
    v_dot2c_f32_bf16 v186, v70, v70
    v_dot2c_f32_bf16 v187, v71, v71
    v_mfma_f32_16x16x32_bf16 v[192:195], v[164:167], v[64:67], v[192:195]
    v_mfma_f32_16x16x32_bf16 v[192:195], v[164:167], v[68:71], v[192:195]
    ds_read_b64_tr_b16 a[8:9], v9 offset:32768
    ds_read_b64_tr_b16 a[10:11], v9 offset:33280
    s_waitcnt lgkmcnt(6)
    v_mfma_f32_32x32x16_bf16 v[128:143], v[76:79], a[0:3], v[128:143]
    s_add_u32 m0, s51, 57344
    s_nop 0
    buffer_load_dwordx4 v3, s[24:27], s72 offen lds
    ds_read_b64_tr_b16 a[12:13], v10 offset:32768
    ds_read_b64_tr_b16 a[14:15], v10 offset:33280
    s_waitcnt lgkmcnt(5)
    v_mfma_f32_32x32x16_bf16 v[128:143], v[80:83], a[4:7], v[128:143]
    v_mfma_f32_16x16x32_bf16 v[160:163], v[164:167], a[4:7], v[160:163]
    s_waitcnt vmcnt(3) lgkmcnt(4)
    s_barrier
    ds_read_b128 v[96:99], v176 offset:16384
    ds_read_b128 v[100:103], v177 offset:16384
    ds_read_b64_tr_b16 a[16:17], v11 offset:32768
    ds_read_b64_tr_b16 a[18:19], v11 offset:33280
    s_waitcnt lgkmcnt(6)
    v_mfma_f32_32x32x16_bf16 v[128:143], v[84:87], a[8:11], v[128:143]
    ds_read_b128 v[104:107], v178 offset:16384
    s_add_u32 s24, s6, s63
    s_addc_u32 s25, s7, 0
    s_sub_u32 s26, s16, s63
    s_mov_b32 s27, 0x20000
    s_add_u32 m0, s51, 65536
    s_nop 0
    buffer_load_dwordx4 v3, s[24:27], s66 offen lds
    v_readfirstlane_b32 s56, v174
    v_readfirstlane_b32 s57, v175
    s_nop 0
    s_cmp_lg_u32 s56, 0
    s_cbranch_scc1 L_tk_a_ok
    s_mov_b32 s80, 0
L_tk_a_spin:
    s_add_u32 s80, s80, 1
    s_cmp_gt_u32 s80, 1048576
    s_cbranch_scc1 L_end
    buffer_load_dwordx2 v[174:175], v173, s[92:95], 0 offen sc1
    s_waitcnt vmcnt(0)
    v_readfirstlane_b32 s56, v174
    v_readfirstlane_b32 s57, v175
    s_nop 0
    s_cmp_lg_u32 s56, 0
    s_cbranch_scc0 L_tk_a_spin
L_tk_a_ok:
    s_add_u32 s79, s79, s57
    v_mov_b32 v174, s56
    v_mov_b32 v175, s79
    s_lshl_b32 s42, s2, 7
    s_add_u32 s42, s42, 13238272
    s_cmp_eq_u32 s36, 0
    s_cselect_b32 s42, s42, 14680064
    s_mov_b64 exec, 1
    buffer_store_dwordx2 v[174:175], v173, s[28:31], s42 offen sc1
    s_mov_b64 exec, -1
    ds_read_b64_tr_b16 a[0:1], v8 offset:40960
    ds_read_b64_tr_b16 a[2:3], v8 offset:41472
    s_waitcnt lgkmcnt(7)
    v_mfma_f32_32x32x16_bf16 v[128:143], v[88:91], a[12:15], v[128:143]
    ds_read_b128 v[108:111], v179 offset:16384
    s_add_u32 m0, s51, 73728
    s_nop 0
    buffer_load_dwordx4 v3, s[24:27], s67 offen lds
    v_dot2c_f32_bf16 v186, v80, v80
    v_dot2c_f32_bf16 v187, v81, v81
    v_dot2c_f32_bf16 v186, v82, v82
    v_dot2c_f32_bf16 v187, v83, v83
    v_dot2c_f32_bf16 v186, v84, v84
    v_dot2c_f32_bf16 v187, v85, v85
    v_dot2c_f32_bf16 v186, v86, v86
    v_dot2c_f32_bf16 v187, v87, v87
    v_mfma_f32_16x16x32_bf16 v[192:195], v[164:167], v[80:83], v[192:195]
    v_mfma_f32_16x16x32_bf16 v[192:195], v[164:167], v[84:87], v[192:195]
    ds_read_b64_tr_b16 a[4:5], v9 offset:40960
    ds_read_b64_tr_b16 a[6:7], v9 offset:41472
    s_waitcnt lgkmcnt(6)
    v_mfma_f32_32x32x16_bf16 v[128:143], v[92:95], a[16:19], v[128:143]
    s_add_u32 m0, s51, 81920
    s_nop 0
    buffer_load_dwordx4 v3, s[24:27], s68 offen lds
    ds_read_b64_tr_b16 a[8:9], v10 offset:40960
    ds_read_b64_tr_b16 a[10:11], v10 offset:41472
    s_waitcnt lgkmcnt(5)
    v_mfma_f32_32x32x16_bf16 v[128:143], v[96:99], a[0:3], v[128:143]
    v_mfma_f32_16x16x32_bf16 v[160:163], v[164:167], a[0:3], v[160:163]
    s_waitcnt vmcnt(4) lgkmcnt(4)
    s_barrier
    ds_read_b128 v[112:115], v176 offset:32768
    ds_read_b128 v[116:119], v177 offset:32768
    ds_read_b64_tr_b16 a[12:13], v11 offset:40960
    ds_read_b64_tr_b16 a[14:15], v11 offset:41472
    s_waitcnt lgkmcnt(6)
    v_mfma_f32_32x32x16_bf16 v[128:143], v[100:103], a[4:7], v[128:143]
    ds_read_b128 v[120:123], v178 offset:32768
    s_add_u32 m0, s51, 90112
    s_nop 0
    buffer_load_dwordx4 v3, s[24:27], s69 offen lds
    ds_read_b64_tr_b16 a[16:17], v8 offset:49152
    ds_read_b64_tr_b16 a[18:19], v8 offset:49664
    s_waitcnt lgkmcnt(7)
    v_mfma_f32_32x32x16_bf16 v[128:143], v[104:107], a[8:11], v[128:143]
    ds_read_b128 v[124:127], v179 offset:32768
    s_add_u32 m0, s51, 98304
    s_nop 0
    buffer_load_dwordx4 v3, s[24:27], s70 offen lds
    v_dot2c_f32_bf16 v186, v96, v96
    v_dot2c_f32_bf16 v187, v97, v97
    v_dot2c_f32_bf16 v186, v98, v98
    v_dot2c_f32_bf16 v187, v99, v99
    v_dot2c_f32_bf16 v186, v100, v100
    v_dot2c_f32_bf16 v187, v101, v101
    v_dot2c_f32_bf16 v186, v102, v102
    v_dot2c_f32_bf16 v187, v103, v103
    v_mfma_f32_16x16x32_bf16 v[192:195], v[164:167], v[96:99], v[192:195]
    v_mfma_f32_16x16x32_bf16 v[192:195], v[164:167], v[100:103], v[192:195]
    ds_read_b64_tr_b16 a[0:1], v9 offset:49152
    ds_read_b64_tr_b16 a[2:3], v9 offset:49664
    s_waitcnt lgkmcnt(6)
    v_mfma_f32_32x32x16_bf16 v[128:143], v[108:111], a[12:15], v[128:143]
    s_add_u32 m0, s51, 106496
    s_nop 0
    buffer_load_dwordx4 v3, s[24:27], s71 offen lds
    ds_read_b64_tr_b16 a[4:5], v10 offset:49152
    ds_read_b64_tr_b16 a[6:7], v10 offset:49664
    s_waitcnt lgkmcnt(5)
    v_mfma_f32_32x32x16_bf16 v[128:143], v[112:115], a[16:19], v[128:143]
    v_mfma_f32_16x16x32_bf16 v[160:163], v[164:167], a[16:19], v[160:163]
    s_waitcnt vmcnt(4)
    s_barrier
    ds_read_b64_tr_b16 a[8:9], v11 offset:49152
    ds_read_b64_tr_b16 a[10:11], v11 offset:49664
    s_waitcnt lgkmcnt(4)
    v_mfma_f32_32x32x16_bf16 v[128:143], v[116:119], a[0:3], v[128:143]
    ds_read_b64_tr_b16 a[12:13], v8 offset:57344
    ds_read_b64_tr_b16 a[14:15], v8 offset:57856
    s_waitcnt lgkmcnt(4)
    v_mfma_f32_32x32x16_bf16 v[128:143], v[120:123], a[4:7], v[128:143]
    v_dot2c_f32_bf16 v186, v112, v112
    v_dot2c_f32_bf16 v187, v113, v113
    v_dot2c_f32_bf16 v186, v114, v114
    v_dot2c_f32_bf16 v187, v115, v115
    v_dot2c_f32_bf16 v186, v116, v116
    v_dot2c_f32_bf16 v187, v117, v117
    v_dot2c_f32_bf16 v186, v118, v118
    v_dot2c_f32_bf16 v187, v119, v119
    v_mfma_f32_16x16x32_bf16 v[192:195], v[164:167], v[112:115], v[192:195]
    v_mfma_f32_16x16x32_bf16 v[192:195], v[164:167], v[116:119], v[192:195]
    ds_read_b64_tr_b16 a[16:17], v9 offset:57344
    ds_read_b64_tr_b16 a[18:19], v9 offset:57856
    s_waitcnt lgkmcnt(4)
    v_mfma_f32_32x32x16_bf16 v[128:143], v[124:127], a[8:11], v[128:143]
    ds_read_b64_tr_b16 a[0:1], v10 offset:57344
    ds_read_b64_tr_b16 a[2:3], v10 offset:57856
    s_waitcnt lgkmcnt(4)
    v_mfma_f32_32x32x16_bf16 v[144:159], v[16:19], a[12:15], 0
    s_add_u32 m0, s51, 114688
    s_nop 0
    buffer_load_dwordx4 v3, s[24:27], s72 offen lds
    ds_read_b64_tr_b16 a[4:5], v11 offset:57344
    ds_read_b64_tr_b16 a[6:7], v11 offset:57856
    v_add_f32 v186, v186, v187
    s_lshl_b32 s84, s37, 1
    v_mov_b32 v187, v186
    s_add_u32 s84, s84, s38
    s_lshl_b32 s84, s84, 8
    s_waitcnt lgkmcnt(4)
    v_mfma_f32_32x32x16_bf16 v[144:159], v[20:23], a[16:19], v[144:159]
    s_add_u32 s24, s6, s64
    s_addc_u32 s25, s7, 0
    s_sub_u32 s26, s16, s64
    s_mov_b32 s27, 0x20000
    s_add_u32 m0, s51, 122880
    s_nop 0
    buffer_load_dwordx4 v4, s[24:27], s66 offen lds
    s_lshl_b32 s42, s38, 6
    v_lshrrev_b32 v174, 5, v1
    v_mul_u32_u24 v7, 1024, v174
    v_bfe_u32 v174, v1, 2, 2
    v_lshl_add_u32 v7, v174, 7, v7
    v_lshrrev_b32 v174, 1, v174
    v_lshlrev_b32 v174, 6, v174
    v_bfe_u32 v175, v1, 4, 1
    v_lshlrev_b32 v175, 5, v175
    v_and_b32 v12, 3, v1
    v_lshl_add_u32 v175, v12, 3, v175
    v_add_u32 v175, s42, v175
    v_xor_b32 v174, v174, v175
    v_add_u32 v7, v7, v174
    s_lshl_b32 s43, s38, 1
    s_xor_b32 s43, s43, s37
    s_lshl_b32 s43, s43, 11
    v_add_u32 v7, s43, v7
    v_add_u32 v8, 65536, v8
    ds_read_b64_tr_b16 a[8:9], v8 offset:0
    ds_read_b64_tr_b16 a[10:11], v8 offset:512
    v_permlane32_swap_b32 v186, v187
    v_mov_b32 v184, v192
    v_add_f32 v185, v186, v187
    v_and_b32 v224, 31, v1
    s_waitcnt lgkmcnt(4)
    v_mfma_f32_32x32x16_bf16 v[144:159], v[24:27], a[0:3], v[144:159]
    s_add_u32 m0, s51, 131072
    s_nop 0
    buffer_load_dwordx4 v4, s[24:27], s67 offen lds
    v_add_u32 v9, 65536, v9
    ds_read_b64_tr_b16 a[12:13], v9 offset:0
    ds_read_b64_tr_b16 a[14:15], v9 offset:512
    v_lshl_add_u32 v224, v224, 3, s84
    ds_write_b64 v224, v[184:185] offset:0
    v_xor_b32 v224, 256, v224
    ds_write_b32 v171, v160 offset:0
    s_waitcnt lgkmcnt(6)
    v_mfma_f32_32x32x16_bf16 v[144:159], v[28:31], a[4:7], v[144:159]
    s_waitcnt vmcnt(5) lgkmcnt(0)
    s_barrier
    v_add_u32 v10, 65536, v10
    ds_read_b64_tr_b16 a[16:17], v10 offset:0
    ds_read_b64_tr_b16 a[18:19], v10 offset:512
    ds_read_b64 v[186:187], v224 offset:0
    s_mov_b32 s45, 1069066811
    s_mov_b32 s60, -1
    s_mov_b32 s61, 0
    s_waitcnt lgkmcnt(0)
    v_add_f32 v184, v184, v186
    v_add_f32 v185, v185, v187
    v_mul_f32 v184, 0xbb124925, v184
    v_mul_f32 v185, 0x3b124925, v185
    v_fma_f32 v185, -v184, v184, v185
    v_mfma_f32_32x32x16_bf16 v[144:159], v[32:35], a[8:11], v[144:159]
    v_mfma_f32_16x16x32_bf16 v[160:163], v[164:167], a[8:11], 0
    s_add_u32 m0, s51, 139264
    s_nop 0
    buffer_load_dwordx4 v4, s[24:27], s68 offen lds
    v_add_u32 v11, 65536, v11
    ds_read_b64_tr_b16 a[0:1], v11 offset:0
    ds_read_b64_tr_b16 a[2:3], v11 offset:512
    v_max_f32 v185, 0, v185
    v_add_f32 v185, 0x3727c5ac, v185
    v_rsq_f32 v185, v185
    v_cvt_pk_bf16_f32 v186, v184, v184
    v_mul_f32 v13, s45, v185
    v_lshlrev_b32 v187, 16, v186
    v_sub_f32 v187, v184, v187
    v_mfma_f32_32x32x16_bf16 v[144:159], v[36:39], a[12:15], v[144:159]
    ds_read_b64_tr_b16 a[4:5], v8 offset:8192
    ds_read_b64_tr_b16 a[6:7], v8 offset:8704
    v_cvt_pk_bf16_f32 v187, v187, 0
    v_cndmask_b32 v14, 0, v186, s[60:61]
    v_cndmask_b32 v15, 0, v187, s[60:61]
    s_lshl_b32 s84, s37, 7
    s_add_u32 s84, s84, 2048
    v_and_b32 v225, 31, v1
    v_lshl_add_u32 v225, v225, 2, s84
    ds_write_b32 v225, v13
    v_lshrrev_b32 v225, 5, v1
    v_mfma_f32_32x32x16_bf16 v[144:159], v[40:43], a[16:19], v[144:159]
    s_add_u32 m0, s51, 147456
    s_nop 0
    buffer_load_dwordx4 v4, s[24:27], s69 offen lds
    ds_read_b64_tr_b16 a[8:9], v9 offset:8192
    ds_read_b64_tr_b16 a[10:11], v9 offset:8704
    v_lshl_add_u32 v225, v225, 4, s84
    ds_read_b128 v[208:211], v225 offset:0
    ds_read_b128 v[212:215], v225 offset:32
    ds_read_b128 v[216:219], v225 offset:64
    ds_read_b128 v[220:223], v225 offset:96
    ds_read_b128 v[224:227], v172 offset:0
    s_waitcnt lgkmcnt(0)
    v_add_f32 v224, v224, v225
    v_add_f32 v226, v226, v227
    v_mfma_f32_32x32x16_bf16 v[144:159], v[44:47], a[0:3], v[144:159]
    ds_read_b64_tr_b16 a[12:13], v10 offset:8192
    ds_read_b64_tr_b16 a[14:15], v10 offset:8704
    v_add_f32 v224, v224, v226
    v_cvt_pk_bf16_f32 v225, v224, v224
    v_lshlrev_b32 v225, 16, v225
    v_sub_f32 v225, v224, v225
    v_cvt_pk_bf16_f32 v168, v224, v225
    v_and_b32 v169, 0xffff, v168
    s_nop 1
    v_mfma_f32_32x32x8bf16_1k v[128:143], v[14:15], v[168:169], v[128:143]
    v_mfma_f32_32x32x16_bf16 v[144:159], v[48:51], a[4:7], v[144:159]
    v_mfma_f32_16x16x32_bf16 v[160:163], v[164:167], a[4:7], v[160:163]
    s_add_u32 m0, s51, 155648
    s_nop 0
    buffer_load_dwordx4 v4, s[24:27], s70 offen lds
    ds_read_b64_tr_b16 a[16:17], v11 offset:8192
    ds_read_b64_tr_b16 a[18:19], v11 offset:8704
    v_mfma_f32_32x32x16_bf16 v[144:159], v[52:55], a[8:11], v[144:159]
    ds_read_b64_tr_b16 a[0:1], v8 offset:16384
    ds_read_b64_tr_b16 a[2:3], v8 offset:16896
    s_waitcnt lgkmcnt(4)
    v_mfma_f32_32x32x16_bf16 v[144:159], v[56:59], a[12:15], v[144:159]
    s_add_u32 m0, s51, 8192
    s_nop 0
    buffer_load_dwordx4 v4, s[24:27], s71 offen lds
    ds_read_b64_tr_b16 a[4:5], v9 offset:16384
    ds_read_b64_tr_b16 a[6:7], v9 offset:16896
    v_mul_f32 v128, v128, v208
    v_mul_f32 v129, v129, v209
    v_mul_f32 v130, v130, v210
    v_mul_f32 v131, v131, v211
    v_mul_f32 v132, v132, v212
    v_mul_f32 v133, v133, v213
    s_waitcnt lgkmcnt(4)
    v_mfma_f32_32x32x16_bf16 v[144:159], v[60:63], a[16:19], v[144:159]
    ds_read_b64_tr_b16 a[8:9], v10 offset:16384
    ds_read_b64_tr_b16 a[10:11], v10 offset:16896
    v_mul_f32 v134, v134, v214
    v_mul_f32 v135, v135, v215
    v_exp_f32_e64 v176, v128 clamp
    v_exp_f32_e64 v177, v129 clamp
    s_waitcnt lgkmcnt(4)
    v_mfma_f32_32x32x16_bf16 v[144:159], v[64:67], a[0:3], v[144:159]
    v_mfma_f32_16x16x32_bf16 v[160:163], v[164:167], a[0:3], v[160:163]
    s_waitcnt vmcnt(6)
    s_barrier
    s_add_u32 m0, s51, 16384
    s_nop 0
    buffer_load_dwordx4 v4, s[24:27], s72 offen lds
    ds_read_b64_tr_b16 a[12:13], v11 offset:16384
    ds_read_b64_tr_b16 a[14:15], v11 offset:16896
    v_exp_f32_e64 v178, v130 clamp
    v_exp_f32_e64 v179, v131 clamp
    v_exp_f32_e64 v180, v132 clamp
    s_waitcnt lgkmcnt(4)
    v_mfma_f32_32x32x16_bf16 v[144:159], v[68:71], a[4:7], v[144:159]
    v_add_u32 v12, 4294959104, v8
    ds_read_b64_tr_b16 a[20:21], v12
    ds_read_b64_tr_b16 a[22:23], v12 offset:512
    ds_read_b64_tr_b16 a[16:17], v8 offset:24576
    ds_read_b64_tr_b16 a[18:19], v8 offset:25088
    v_exp_f32_e64 v181, v133 clamp
    v_exp_f32_e64 v182, v134 clamp
    v_exp_f32_e64 v183, v135 clamp
    s_waitcnt lgkmcnt(6)
    v_mfma_f32_32x32x16_bf16 v[144:159], v[72:75], a[8:11], v[144:159]
    v_add_u32 v12, 24576, v8
    ds_read_b64_tr_b16 a[24:25], v12
    ds_read_b64_tr_b16 a[26:27], v12 offset:512
    ds_read_b64_tr_b16 a[0:1], v9 offset:24576
    ds_read_b64_tr_b16 a[2:3], v9 offset:25088
    v_max_f32 v128, 0, v128
    v_max_f32 v129, 0, v129
    v_max_f32 v130, 0, v130
    v_max_f32 v131, 0, v131
    v_max_f32 v132, 0, v132
    s_waitcnt lgkmcnt(8)
    v_mfma_f32_32x32x16_bf16 v[144:159], v[76:79], a[12:15], v[144:159]
    s_waitcnt lgkmcnt(6)
    v_mfma_f32_16x16x32_bf16 v[160:163], v[164:167], a[20:23], v[160:163]
    v_add_u32 v12, 32768, v8
    ds_read_b64_tr_b16 a[20:21], v12
    ds_read_b64_tr_b16 a[22:23], v12 offset:512
    ds_read_b64_tr_b16 a[4:5], v10 offset:24576
    ds_read_b64_tr_b16 a[6:7], v10 offset:25088
    v_max_f32 v133, 0, v133
    v_max_f32 v134, 0, v134
    v_max_f32 v135, 0, v135
    v_fma_f32 v128, v128, s74, v170
    v_fma_f32 v129, v129, s74, v170
    v_fma_f32 v130, v130, s74, v170
    s_waitcnt lgkmcnt(8)
    v_mfma_f32_32x32x16_bf16 v[144:159], v[80:83], a[16:19], v[144:159]
    s_lshl_b32 s10, s37, 3
    s_lshr_b32 s10, 117835012, s10
    s_and_b32 s10, s10, 31
    s_lshl_b32 s10, s10, 13
    s_lshl_b32 s17, s38, 12
    s_add_u32 s10, s10, s17
    s_mul_i32 s86, s37, 401408
    s_lshl_b32 s17, s82, 7
    s_add_u32 s86, s86, s17
    s_mul_i32 s17, s38, 28672
    s_add_u32 s86, s86, s17
    s_add_u32 s87, s83, 0
    s_cmp_ge_u32 s87, 7
    s_cselect_b32 s17, 7, 0
    s_sub_u32 s87, s87, s17
    s_mul_i32 s87, s87, 57344
    s_add_u32 s86, s86, s87
    s_add_u32 m0, s10, 0
    s_nop 0
    buffer_load_dwordx4 v5, s[32:35], s86 offen lds
    s_waitcnt lgkmcnt(6)
    v_mfma_f32_16x16x32_bf16 v[160:163], v[164:167], a[24:27], v[160:163]
    v_add_u32 v12, 40960, v8
    ds_read_b64_tr_b16 a[24:25], v12
    ds_read_b64_tr_b16 a[26:27], v12 offset:512
    ds_read_b64_tr_b16 a[8:9], v11 offset:24576
    ds_read_b64_tr_b16 a[10:11], v11 offset:25088
    v_fma_f32 v131, v131, s74, v170
    v_fma_f32 v132, v132, s74, v170
    v_fma_f32 v133, v133, s74, v170
    v_fma_f32 v134, v134, s74, v170
    v_fma_f32 v135, v135, s74, v170
    s_waitcnt lgkmcnt(8)
    v_mfma_f32_32x32x16_bf16 v[144:159], v[84:87], a[0:3], v[144:159]
    s_waitcnt lgkmcnt(6)
    v_mfma_f32_16x16x32_bf16 v[160:163], v[164:167], a[20:23], v[160:163]
    ds_read_b64_tr_b16 a[12:13], v8 offset:32768
    ds_read_b64_tr_b16 a[14:15], v8 offset:33280
    v_add_f32 v176, v128, v176
    v_add_f32 v177, v129, v177
    v_add_f32 v178, v130, v178
    v_add_f32 v179, v131, v179
    v_add_f32 v180, v132, v180
    v_add_f32 v181, v133, v181
    s_waitcnt lgkmcnt(6)
    v_mfma_f32_32x32x16_bf16 v[144:159], v[88:91], a[4:7], v[144:159]
    s_add_u32 m0, s10, 1024
    s_add_u32 s86, s86, 7168
    buffer_load_dwordx4 v5, s[32:35], s86 offen lds
    s_waitcnt lgkmcnt(4)
    v_mfma_f32_16x16x32_bf16 v[160:163], v[164:167], a[24:27], v[160:163]
    ds_read_b64_tr_b16 a[16:17], v9 offset:32768
    ds_read_b64_tr_b16 a[18:19], v9 offset:33280
    v_add_f32 v182, v134, v182
    v_add_f32 v183, v135, v183
    v_cvt_pk_bf16_f32 v192, v176, v177
    v_cvt_pk_bf16_f32 v193, v178, v179
    v_cvt_pk_bf16_f32 v194, v180, v181
    v_cvt_pk_bf16_f32 v195, v182, v183
    s_waitcnt lgkmcnt(4)
    v_mfma_f32_32x32x16_bf16 v[144:159], v[92:95], a[8:11], v[144:159]
    ds_read_b64_tr_b16 a[0:1], v10 offset:32768
    ds_read_b64_tr_b16 a[2:3], v10 offset:33280
    v_mul_f32 v136, v136, v216
    v_mul_f32 v137, v137, v217
    v_mul_f32 v138, v138, v218
    v_mul_f32 v139, v139, v219
    v_mul_f32 v140, v140, v220
    v_mul_f32 v141, v141, v221
    s_waitcnt lgkmcnt(4)
    v_mfma_f32_32x32x16_bf16 v[144:159], v[96:99], a[12:15], v[144:159]
    s_add_u32 m0, s10, 2048
    s_add_u32 s86, s86, 7168
    buffer_load_dwordx4 v5, s[32:35], s86 offen lds
    ds_read_b64_tr_b16 a[4:5], v11 offset:32768
    ds_read_b64_tr_b16 a[6:7], v11 offset:33280
    v_mul_f32 v142, v142, v222
    v_mul_f32 v143, v143, v223
    v_exp_f32_e64 v176, v136 clamp
    v_exp_f32_e64 v177, v137 clamp
    s_waitcnt lgkmcnt(4)
    v_mfma_f32_32x32x16_bf16 v[144:159], v[100:103], a[16:19], v[144:159]
    ds_write_b32 v171, v160 offset:1024
    ds_read_b64_tr_b16 a[8:9], v8 offset:40960
    ds_read_b64_tr_b16 a[10:11], v8 offset:41472
    v_exp_f32_e64 v178, v138 clamp
    v_exp_f32_e64 v179, v139 clamp
    v_exp_f32_e64 v180, v140 clamp
    s_waitcnt lgkmcnt(5)
    v_mfma_f32_32x32x16_bf16 v[144:159], v[104:107], a[0:3], v[144:159]
    s_add_u32 m0, s10, 3072
    s_add_u32 s86, s86, 7168
    buffer_load_dwordx4 v5, s[32:35], s86 offen lds
    v_lshlrev_b32 v3, 7, v1
    s_mov_b64 exec, 65535
    buffer_load_dword v4, v3, s[28:31], s4 offen
    s_mov_b64 exec, -1
    ds_read_b64_tr_b16 a[12:13], v9 offset:40960
    ds_read_b64_tr_b16 a[14:15], v9 offset:41472
    v_exp_f32_e64 v181, v141 clamp
    v_exp_f32_e64 v182, v142 clamp
    v_exp_f32_e64 v183, v143 clamp
    s_waitcnt lgkmcnt(5)
    v_mfma_f32_32x32x16_bf16 v[144:159], v[108:111], a[4:7], v[144:159]
    ds_read_b64_tr_b16 a[16:17], v10 offset:40960
    ds_read_b64_tr_b16 a[18:19], v10 offset:41472
    v_max_f32 v136, 0, v136
    v_max_f32 v137, 0, v137
    v_max_f32 v138, 0, v138
    v_max_f32 v139, 0, v139
    v_max_f32 v140, 0, v140
    s_waitcnt lgkmcnt(4)
    v_mfma_f32_32x32x16_bf16 v[144:159], v[112:115], a[8:11], v[144:159]
    s_waitcnt vmcnt(8)
    s_barrier
    ds_read_b128 v[224:227], v172 offset:1024
    ds_read_b64_tr_b16 a[0:1], v11 offset:40960
    ds_read_b64_tr_b16 a[2:3], v11 offset:41472
    v_max_f32 v141, 0, v141
    v_max_f32 v142, 0, v142
    v_max_f32 v143, 0, v143
    v_fma_f32 v136, v136, s74, v170
    v_fma_f32 v137, v137, s74, v170
    v_fma_f32 v138, v138, s74, v170
    s_waitcnt lgkmcnt(5)
    v_mfma_f32_32x32x16_bf16 v[144:159], v[116:119], a[12:15], v[144:159]
    v_add_u32 v8, 122880, v7
    ds_read_b64_tr_b16 a[4:5], v8 offset:0
    ds_read_b64_tr_b16 a[6:7], v8 offset:512
    v_fma_f32 v139, v139, s74, v170
    v_fma_f32 v140, v140, s74, v170
    v_fma_f32 v141, v141, s74, v170
    v_fma_f32 v142, v142, s74, v170
    v_fma_f32 v143, v143, s74, v170
    s_waitcnt lgkmcnt(5)
    v_mfma_f32_32x32x16_bf16 v[144:159], v[120:123], a[16:19], v[144:159]
    s_waitcnt lgkmcnt(4)
    v_add_f32 v224, v224, v225
    v_add_f32 v226, v226, v227
    v_add_f32 v224, v224, v226
    v_cvt_pk_bf16_f32 v225, v224, v224
    v_xor_b32 v9, 2048, v7
    v_add_u32 v9, 122880, v9
    ds_read_b64_tr_b16 a[8:9], v9 offset:0
    ds_read_b64_tr_b16 a[10:11], v9 offset:512
    v_add_f32 v176, v136, v176
    v_add_f32 v177, v137, v177
    v_add_f32 v178, v138, v178
    v_add_f32 v179, v139, v179
    v_add_f32 v180, v140, v180
    v_add_f32 v181, v141, v181
    s_waitcnt lgkmcnt(4)
    v_mfma_f32_32x32x16_bf16 v[144:159], v[124:127], a[0:3], v[144:159]
    v_lshlrev_b32 v225, 16, v225
    v_sub_f32 v225, v224, v225
    v_cvt_pk_bf16_f32 v168, v224, v225
    v_and_b32 v169, 0xffff, v168
    v_xor_b32 v10, 4096, v7
    v_add_u32 v10, 122880, v10
    ds_read_b64_tr_b16 a[12:13], v10 offset:0
    ds_read_b64_tr_b16 a[14:15], v10 offset:512
    v_add_f32 v182, v142, v182
    v_add_f32 v183, v143, v183
    v_cvt_pk_bf16_f32 v196, v176, v177
    v_cvt_pk_bf16_f32 v197, v178, v179
    v_cvt_pk_bf16_f32 v198, v180, v181
    v_cvt_pk_bf16_f32 v199, v182, v183
    v_mfma_f32_32x32x8bf16_1k v[144:159], v[14:15], v[168:169], v[144:159]
    s_cmp_eq_u32 s40, 7
    s_cbranch_scc1 L_red
    s_waitcnt lgkmcnt(4)
    v_mfma_f32_32x32x16_bf16 v[128:143], a[4:7], v[16:19], 0
    v_mfma_f32_16x16x32_bf16 v[160:163], v[164:167], a[4:7], 0
    v_xor_b32 v11, 6144, v7
    v_add_u32 v11, 122880, v11
    ds_read_b64_tr_b16 a[16:17], v11 offset:0
    ds_read_b64_tr_b16 a[18:19], v11 offset:512
    s_waitcnt lgkmcnt(4)
    v_mfma_f32_32x32x16_bf16 v[128:143], a[8:11], v[20:23], v[128:143]
    ds_read_b64_tr_b16 a[0:1], v8 offset:8192
    ds_read_b64_tr_b16 a[2:3], v8 offset:8704
    v_mul_f32 v144, v144, v208
    v_mul_f32 v145, v145, v209
    v_mul_f32 v146, v146, v210
    v_mul_f32 v147, v147, v211
    v_mul_f32 v148, v148, v212
    v_mul_f32 v149, v149, v213
    v_mul_f32 v150, v150, v214
    v_mul_f32 v151, v151, v215
    v_mul_f32 v152, v152, v216
    s_waitcnt lgkmcnt(4)
    v_mfma_f32_32x32x16_bf16 v[128:143], a[12:15], v[24:27], v[128:143]
    ds_read_b64_tr_b16 a[4:5], v9 offset:8192
    ds_read_b64_tr_b16 a[6:7], v9 offset:8704
    v_mul_f32 v153, v153, v217
    v_mul_f32 v154, v154, v218
    v_mul_f32 v155, v155, v219
    v_mul_f32 v156, v156, v220
    v_mul_f32 v157, v157, v221
    v_mul_f32 v158, v158, v222
    v_mul_f32 v159, v159, v223
    v_mov_b32 v176, s44
    v_mov_b32 v177, 0
    s_waitcnt lgkmcnt(4)
    v_mfma_f32_32x32x16_bf16 v[128:143], a[16:19], v[28:31], v[128:143]
    ds_read_b64_tr_b16 a[8:9], v10 offset:8192
    ds_read_b64_tr_b16 a[10:11], v10 offset:8704
    v_cvt_pk_bf16_f32 v200, v144, v145
    v_cvt_pk_bf16_f32 v201, v146, v147
    v_cvt_pk_bf16_f32 v202, v148, v149
    v_cvt_pk_bf16_f32 v203, v150, v151
    v_cvt_pk_bf16_f32 v204, v152, v153
    v_cvt_pk_bf16_f32 v205, v154, v155
    v_cvt_pk_bf16_f32 v206, v156, v157
    v_cvt_pk_bf16_f32 v207, v158, v159
    v_cndmask_b32 v200, v200, v176, s[54:55]
    v_cndmask_b32 v201, v201, v176, s[54:55]
    s_waitcnt lgkmcnt(4)
    v_mfma_f32_32x32x16_bf16 v[128:143], a[0:3], v[32:35], v[128:143]
    v_mfma_f32_16x16x32_bf16 v[160:163], v[164:167], a[0:3], v[160:163]
    ds_read_b64_tr_b16 a[12:13], v11 offset:8192
    ds_read_b64_tr_b16 a[14:15], v11 offset:8704
    v_cndmask_b32 v202, v202, v176, s[54:55]
    v_cndmask_b32 v203, v203, v176, s[54:55]
    v_cndmask_b32 v204, v204, v176, s[54:55]
    v_cndmask_b32 v205, v205, v176, s[54:55]
    v_cndmask_b32 v206, v206, v176, s[54:55]
    v_cndmask_b32 v207, v207, v176, s[54:55]
    v_mfma_f32_32x32x16_bf16 v[144:159], v[192:195], v[200:203], 0
    s_waitcnt lgkmcnt(4)
    v_mfma_f32_32x32x16_bf16 v[128:143], a[4:7], v[36:39], v[128:143]
    ds_read_b64_tr_b16 a[16:17], v8 offset:16384
    ds_read_b64_tr_b16 a[18:19], v8 offset:16896
    v_mfma_f32_32x32x16_bf16 v[144:159], v[196:199], v[204:207], v[144:159]
    s_lshl_b32 s84, s37, 1
    s_add_u32 s84, s84, s38
    s_lshl_b32 s84, s84, 12
    s_add_u32 s84, s84, 65536
    v_add_u32 v6, s84, v2
    s_sub_u32 s59, s38, 1
    s_mov_b32 s58, 0
    s_sub_u32 s54, 0, s38
    s_mov_b32 s55, 0
    s_nop 2
    v_cndmask_b32 v156, v156, v177, s[58:59]
    v_cndmask_b32 v157, v157, v177, s[58:59]
    v_cndmask_b32 v158, v158, v177, s[58:59]
    s_waitcnt lgkmcnt(4)
    v_mfma_f32_32x32x16_bf16 v[128:143], a[8:11], v[40:43], v[128:143]
    ds_read_b64_tr_b16 a[0:1], v9 offset:16384
    ds_read_b64_tr_b16 a[2:3], v9 offset:16896
    v_cndmask_b32 v159, v159, v177, s[58:59]
    v_cndmask_b32 v144, v144, v177, s[54:55]
    v_cndmask_b32 v145, v145, v177, s[54:55]
    v_cndmask_b32 v146, v146, v177, s[54:55]
    v_cndmask_b32 v147, v147, v177, s[54:55]
    ds_write_b128 v6, v[144:147] offset:0
    ds_write_b128 v6, v[148:151] offset:1024
    ds_write_b128 v6, v[152:155] offset:2048
    ds_write_b128 v6, v[156:159] offset:3072
    s_waitcnt lgkmcnt(8)
    v_mfma_f32_32x32x16_bf16 v[128:143], a[12:15], v[44:47], v[128:143]
    s_waitcnt lgkmcnt(0)
    s_barrier
    ds_read_b64_tr_b16 a[4:5], v10 offset:16384
    ds_read_b64_tr_b16 a[6:7], v10 offset:16896
    v_mfma_f32_32x32x16_bf16 v[128:143], a[16:19], v[48:51], v[128:143]
    v_mfma_f32_16x16x32_bf16 v[160:163], v[164:167], a[16:19], v[160:163]
    ds_read_b64_tr_b16 a[8:9], v11 offset:16384
    ds_read_b64_tr_b16 a[10:11], v11 offset:16896
    s_lshl_b32 s84, s38, 12
    s_lshl_b32 s85, s37, 10
    s_add_u32 s84, s84, s85
    s_add_u32 s84, s84, 65536
    v_add_u32 v6, s84, v2
    ds_read_b128 v[144:147], v6 offset:0
    ds_read_b128 v[148:151], v6 offset:8192
    ds_read_b128 v[152:155], v6 offset:16384
    ds_read_b128 v[156:159], v6 offset:24576
    v_mfma_f32_32x32x16_bf16 v[128:143], a[0:3], v[52:55], v[128:143]
    ds_read_b64_tr_b16 a[12:13], v8 offset:24576
    ds_read_b64_tr_b16 a[14:15], v8 offset:25088
    s_waitcnt lgkmcnt(4)
    v_add_f32 v144, v144, v148
    s_waitcnt lgkmcnt(2)
    v_add_f32 v152, v152, v156
    v_add_f32 v145, v145, v149
    v_add_f32 v153, v153, v157
    v_add_f32 v146, v146, v150
    v_add_f32 v154, v154, v158
    v_mfma_f32_32x32x16_bf16 v[128:143], a[4:7], v[56:59], v[128:143]
    ds_read_b64_tr_b16 a[16:17], v9 offset:24576
    ds_read_b64_tr_b16 a[18:19], v9 offset:25088
    v_add_f32 v147, v147, v151
    v_add_f32 v155, v155, v159
    v_add_f32 v144, v144, v152
    v_add_f32 v145, v145, v153
    v_add_f32 v146, v146, v154
    v_add_f32 v147, v147, v155
    buffer_store_dwordx4 v[144:147], v2, s[28:31], s75 offen sc1
    v_mfma_f32_32x32x16_bf16 v[128:143], a[8:11], v[60:63], v[128:143]
    ds_read_b64_tr_b16 a[0:1], v10 offset:24576
    ds_read_b64_tr_b16 a[2:3], v10 offset:25088
    s_waitcnt lgkmcnt(4)
    v_mfma_f32_32x32x16_bf16 v[128:143], a[12:15], v[64:67], v[128:143]
    v_mfma_f32_16x16x32_bf16 v[160:163], v[164:167], a[12:15], v[160:163]
    s_waitcnt vmcnt(6)
    s_barrier
    ds_read_b64_tr_b16 a[4:5], v11 offset:24576
    ds_read_b64_tr_b16 a[6:7], v11 offset:25088
    s_waitcnt lgkmcnt(4)
    v_mfma_f32_32x32x16_bf16 v[128:143], a[16:19], v[68:71], v[128:143]
    v_add_u32 v12, 32768, v8
    ds_read_b64_tr_b16 a[20:21], v12
    ds_read_b64_tr_b16 a[22:23], v12 offset:512
    ds_read_b64_tr_b16 a[8:9], v8 offset:32768
    ds_read_b64_tr_b16 a[10:11], v8 offset:33280
    s_waitcnt lgkmcnt(6)
    v_mfma_f32_32x32x16_bf16 v[128:143], a[0:3], v[72:75], v[128:143]
    s_lshl_b32 s10, s37, 3
    s_lshr_b32 s10, 235736067, s10
    s_and_b32 s10, s10, 31
    s_lshl_b32 s10, s10, 13
    s_lshl_b32 s17, s38, 12
    s_add_u32 s10, s10, s17
    s_mul_i32 s86, s37, 401408
    s_lshl_b32 s17, s82, 7
    s_add_u32 s86, s86, s17
    s_mul_i32 s17, s38, 28672
    s_add_u32 s86, s86, s17
    s_add_u32 s87, s83, 1
    s_cmp_ge_u32 s87, 7
    s_cselect_b32 s17, 7, 0
    s_sub_u32 s87, s87, s17
    s_mul_i32 s87, s87, 57344
    s_add_u32 s86, s86, s87
    s_add_u32 m0, s10, 0
    s_nop 0
    buffer_load_dwordx4 v5, s[32:35], s86 offen lds
    v_add_u32 v12, 4294852608, v8
    ds_read_b64_tr_b16 a[24:25], v12
    ds_read_b64_tr_b16 a[26:27], v12 offset:512
    ds_read_b64_tr_b16 a[12:13], v9 offset:32768
    ds_read_b64_tr_b16 a[14:15], v9 offset:33280
    s_waitcnt lgkmcnt(8)
    v_mfma_f32_32x32x16_bf16 v[128:143], a[4:7], v[76:79], v[128:143]
    s_waitcnt lgkmcnt(6)
    v_mfma_f32_16x16x32_bf16 v[160:163], v[164:167], a[20:23], v[160:163]
    v_add_u32 v12, 4294860800, v8
    ds_read_b64_tr_b16 a[20:21], v12
    ds_read_b64_tr_b16 a[22:23], v12 offset:512
    ds_read_b64_tr_b16 a[16:17], v10 offset:32768
    ds_read_b64_tr_b16 a[18:19], v10 offset:33280
    s_waitcnt lgkmcnt(8)
    v_mfma_f32_32x32x16_bf16 v[128:143], a[8:11], v[80:83], v[128:143]
    s_add_u32 m0, s10, 1024
    s_add_u32 s86, s86, 7168
    buffer_load_dwordx4 v5, s[32:35], s86 offen lds
    s_waitcnt lgkmcnt(6)
    v_mfma_f32_16x16x32_bf16 v[160:163], v[164:167], a[24:27], v[160:163]
    ds_read_b64_tr_b16 a[0:1], v11 offset:32768
    ds_read_b64_tr_b16 a[2:3], v11 offset:33280
    s_waitcnt lgkmcnt(6)
    v_mfma_f32_32x32x16_bf16 v[128:143], a[12:15], v[84:87], v[128:143]
    s_waitcnt lgkmcnt(4)
    v_mfma_f32_16x16x32_bf16 v[160:163], v[164:167], a[20:23], v[160:163]
    v_add_u32 v8, 4294852608, v8
    ds_read_b64_tr_b16 a[4:5], v8 offset:0
    ds_read_b64_tr_b16 a[6:7], v8 offset:512
    s_waitcnt lgkmcnt(4)
    v_mfma_f32_32x32x16_bf16 v[128:143], a[16:19], v[88:91], v[128:143]
    v_add_u32 v9, 4294852608, v9
    ds_read_b64_tr_b16 a[8:9], v9 offset:0
    ds_read_b64_tr_b16 a[10:11], v9 offset:512
    s_waitcnt lgkmcnt(4)
    v_mfma_f32_32x32x16_bf16 v[128:143], a[0:3], v[92:95], v[128:143]
    s_add_u32 m0, s10, 2048
    s_add_u32 s86, s86, 7168
    buffer_load_dwordx4 v5, s[32:35], s86 offen lds
    v_add_u32 v10, 4294852608, v10
    ds_read_b64_tr_b16 a[12:13], v10 offset:0
    ds_read_b64_tr_b16 a[14:15], v10 offset:512
    s_waitcnt lgkmcnt(4)
    v_mfma_f32_32x32x16_bf16 v[128:143], a[4:7], v[96:99], v[128:143]
    v_add_u32 v11, 4294852608, v11
    ds_read_b64_tr_b16 a[16:17], v11 offset:0
    ds_read_b64_tr_b16 a[18:19], v11 offset:512
    s_waitcnt lgkmcnt(4)
    v_mfma_f32_32x32x16_bf16 v[128:143], a[8:11], v[100:103], v[128:143]
    ds_write_b32 v171, v160 offset:0
    s_add_u32 m0, s10, 3072
    s_add_u32 s86, s86, 7168
    buffer_load_dwordx4 v5, s[32:35], s86 offen lds
    ds_read_b64_tr_b16 a[0:1], v8 offset:8192
    ds_read_b64_tr_b16 a[2:3], v8 offset:8704
    s_waitcnt lgkmcnt(5)
    v_mfma_f32_32x32x16_bf16 v[128:143], a[12:15], v[104:107], v[128:143]
    ds_read_b64_tr_b16 a[4:5], v9 offset:8192
    ds_read_b64_tr_b16 a[6:7], v9 offset:8704
    s_waitcnt lgkmcnt(5)
    v_mfma_f32_32x32x16_bf16 v[128:143], a[16:19], v[108:111], v[128:143]
    s_and_b32 s42, s2, 7
    s_lshl_b32 s42, s42, 7
    v_and_b32 v173, 31, v1
    v_lshlrev_b32 v173, 10, v173
    v_add_u32 v173, s42, v173
    v_and_b32 v174, 15, v1
    v_lshlrev_b32 v174, 7, v174
    v_add_u32 v174, 30720, v174
    v_cmp_gt_u32 vcc, 32, v1
    s_nop 1
    v_cndmask_b32 v173, v174, v173, vcc
    v_add_u32 v173, 13238272, v173
    buffer_load_dwordx2 v[174:175], v173, s[28:31], 0 offen sc1
    ds_read_b64_tr_b16 a[8:9], v10 offset:8192
    ds_read_b64_tr_b16 a[10:11], v10 offset:8704
    s_waitcnt lgkmcnt(4)
    v_mfma_f32_32x32x16_bf16 v[128:143], a[0:3], v[112:115], v[128:143]
    s_barrier
    ds_read_b128 v[224:227], v172 offset:0
    ds_read_b64_tr_b16 a[12:13], v11 offset:8192
    ds_read_b64_tr_b16 a[14:15], v11 offset:8704
    s_waitcnt lgkmcnt(5)
    v_mfma_f32_32x32x16_bf16 v[128:143], a[4:7], v[116:119], v[128:143]
    s_waitcnt lgkmcnt(3)
    v_mfma_f32_32x32x16_bf16 v[128:143], a[8:11], v[120:123], v[128:143]
    s_waitcnt lgkmcnt(2)
    v_add_f32 v224, v224, v225
    v_add_f32 v226, v226, v227
    v_add_f32 v224, v224, v226
    v_cvt_pk_bf16_f32 v225, v224, v224
    s_waitcnt lgkmcnt(0)
    v_mfma_f32_32x32x16_bf16 v[128:143], a[12:15], v[124:127], v[128:143]
    v_lshlrev_b32 v225, 16, v225
    v_sub_f32 v225, v224, v225
    v_cvt_pk_bf16_f32 v168, v224, v225
    v_and_b32 v169, 0xffff, v168
    s_nop 1
    v_mfma_f32_32x32x8bf16_1k v[128:143], v[168:169], v[14:15], v[128:143]
    s_barrier
    s_lshl_b32 s10, s37, 13
    s_add_u32 s10, s10, s18
    s_lshl_b32 s17, s38, 12
    s_add_u32 s10, s10, s17
    s_mul_i32 s86, s37, 100352
    s_lshl_b32 s17, s82, 7
    s_add_u32 s86, s86, s17
    s_mul_i32 s17, s38, 28672
    s_add_u32 s86, s86, s17
    s_mov_b32 s87, 0
    s_add_u32 s86, s86, s87
    s_add_u32 m0, s10, 0
    s_nop 0
    buffer_load_dwordx4 v5, s[88:91], s86 offen lds
    v_mul_f32 v128, v128, v13
    v_mul_f32 v129, v129, v13
    v_mul_f32 v130, v130, v13
    v_mul_f32 v131, v131, v13
    v_mul_f32 v132, v132, v13
    v_mul_f32 v133, v133, v13
    v_mul_f32 v134, v134, v13
    v_mul_f32 v135, v135, v13
    v_exp_f32_e64 v176, v128 clamp
    v_exp_f32_e64 v177, v129 clamp
    s_add_u32 m0, s10, 1024
    s_add_u32 s86, s86, 7168
    buffer_load_dwordx4 v5, s[88:91], s86 offen lds
    v_exp_f32_e64 v178, v130 clamp
    v_exp_f32_e64 v179, v131 clamp
    v_exp_f32_e64 v180, v132 clamp
    v_exp_f32_e64 v181, v133 clamp
    v_exp_f32_e64 v182, v134 clamp
    v_exp_f32_e64 v183, v135 clamp
    v_max_f32 v128, 0, v128
    v_max_f32 v129, 0, v129
    v_max_f32 v130, 0, v130
    v_max_f32 v131, 0, v131
    s_add_u32 m0, s10, 2048
    s_add_u32 s86, s86, 7168
    buffer_load_dwordx4 v5, s[88:91], s86 offen lds
    v_max_f32 v132, 0, v132
    v_max_f32 v133, 0, v133
    v_max_f32 v134, 0, v134
    v_max_f32 v135, 0, v135
    v_fma_f32 v128, v128, s74, v170
    v_fma_f32 v129, v129, s74, v170
    v_fma_f32 v130, v130, s74, v170
    v_fma_f32 v131, v131, s74, v170
    v_fma_f32 v132, v132, s74, v170
    v_fma_f32 v133, v133, s74, v170
    s_add_u32 m0, s10, 3072
    s_add_u32 s86, s86, 7168
    buffer_load_dwordx4 v5, s[88:91], s86 offen lds
    v_fma_f32 v134, v134, s74, v170
    v_fma_f32 v135, v135, s74, v170
    v_add_f32 v176, v128, v176
    v_add_f32 v177, v129, v177
    v_add_f32 v178, v130, v178
    v_add_f32 v179, v131, v179
    v_add_f32 v180, v132, v180
    v_add_f32 v181, v133, v181
    v_add_f32 v182, v134, v182
    v_add_f32 v183, v135, v183
    v_cvt_pk_bf16_f32 v184, v176, v177
    v_cvt_pk_bf16_f32 v185, v178, v179
    v_cvt_pk_bf16_f32 v186, v180, v181
    v_cvt_pk_bf16_f32 v187, v182, v183
    buffer_store_dwordx4 v[184:187], v2, s[28:31], s4 offen offset:0
    v_mul_f32 v136, v136, v13
    v_mul_f32 v137, v137, v13
    v_mul_f32 v138, v138, v13
    v_mul_f32 v139, v139, v13
    v_mul_f32 v140, v140, v13
    v_mul_f32 v141, v141, v13
    v_mul_f32 v142, v142, v13
    v_mul_f32 v143, v143, v13
    v_exp_f32_e64 v176, v136 clamp
    v_exp_f32_e64 v177, v137 clamp
    v_exp_f32_e64 v178, v138 clamp
    v_exp_f32_e64 v179, v139 clamp
    v_exp_f32_e64 v180, v140 clamp
    v_exp_f32_e64 v181, v141 clamp
    v_exp_f32_e64 v182, v142 clamp
    v_exp_f32_e64 v183, v143 clamp
    v_max_f32 v136, 0, v136
    v_max_f32 v137, 0, v137
    v_max_f32 v138, 0, v138
    v_max_f32 v139, 0, v139
    v_max_f32 v140, 0, v140
    v_max_f32 v141, 0, v141
    v_max_f32 v142, 0, v142
    v_max_f32 v143, 0, v143
    v_fma_f32 v136, v136, s74, v170
    v_fma_f32 v137, v137, s74, v170
    v_fma_f32 v138, v138, s74, v170
    v_fma_f32 v139, v139, s74, v170
    v_fma_f32 v140, v140, s74, v170
    v_fma_f32 v141, v141, s74, v170
    v_fma_f32 v142, v142, s74, v170
    v_fma_f32 v143, v143, s74, v170
    v_add_f32 v176, v136, v176
    v_add_f32 v177, v137, v177
    v_add_f32 v178, v138, v178
    v_add_f32 v179, v139, v179
    v_add_f32 v180, v140, v180
    v_add_f32 v181, v141, v181
    v_add_f32 v182, v142, v182
    v_add_f32 v183, v143, v183
    v_cvt_pk_bf16_f32 v188, v176, v177
    v_cvt_pk_bf16_f32 v189, v178, v179
    v_cvt_pk_bf16_f32 v190, v180, v181
    v_cvt_pk_bf16_f32 v191, v182, v183
    buffer_store_dwordx4 v[188:191], v2, s[28:31], s4 offen offset:1024
    s_waitcnt vmcnt(6)
    v_subrev_u32 v224, s57, v175
    v_cmp_ne_u32 vcc, s56, v174
    v_cmp_lt_u32 s[60:61], 15, v224
    s_nop 4
    s_or_b64 vcc, vcc, s[60:61]
    s_cmp_eq_u64 vcc, 0
    s_cbranch_scc1 L_px_a_ok
    s_mov_b32 s80, 0
L_px_a_spin:
    s_add_u32 s80, s80, 1
    s_cmp_gt_u32 s80, 1048576
    s_cbranch_scc1 L_end
    buffer_load_dwordx2 v[174:175], v173, s[28:31], 0 offen sc1
    s_waitcnt vmcnt(0)
    v_subrev_u32 v224, s57, v175
    v_cmp_ne_u32 vcc, s56, v174
    v_cmp_lt_u32 s[60:61], 15, v224
    s_nop 4
    s_or_b64 vcc, vcc, s[60:61]
    s_cmp_eq_u64 vcc, 0
    s_cbranch_scc0 L_px_a_spin
L_px_a_ok:
    v_cmp_ne_u32 vcc, s79, v175
    s_nop 4
    s_cmp_eq_u32 vcc_lo, 0
    s_cselect_b32 s79, 1, 0
    v_mov_b32 v224, s56
    v_mov_b32 v225, s57
    v_mov_b32 v226, 0
    s_waitcnt vmcnt(0)
    s_mov_b64 exec, 1
    s_cmp_eq_u32 s79, 1
    s_cbranch_scc1 L_fast_a
    buffer_wbl2 sc1
    s_waitcnt vmcnt(0)
    buffer_store_dwordx2 v[224:225], v226, s[28:31], s76 offen sc1
    s_branch L_pub_a
L_fast_a:
    buffer_store_dwordx2 v[224:225], v226, s[28:31], s76 offen
L_pub_a:
    s_mov_b64 exec, -1
    s_lshl_b32 s10, s37, 13
    s_add_u32 s10, s10, s19
    s_lshl_b32 s17, s38, 12
    s_add_u32 s10, s10, s17
    s_mul_i32 s86, s37, 401408
    s_lshl_b32 s17, s82, 7
    s_add_u32 s86, s86, s17
    s_mul_i32 s17, s38, 28672
    s_add_u32 s86, s86, s17
    s_add_u32 s87, s83, 2
    s_cmp_ge_u32 s87, 7
    s_cselect_b32 s17, 7, 0
    s_sub_u32 s87, s87, s17
    s_mul_i32 s87, s87, 57344
    s_add_u32 s86, s86, s87
    s_add_u32 m0, s10, 0
    s_nop 0
    buffer_load_dwordx4 v5, s[32:35], s86 offen lds
    s_add_u32 m0, s10, 1024
    s_add_u32 s86, s86, 7168
    buffer_load_dwordx4 v5, s[32:35], s86 offen lds
    s_add_u32 m0, s10, 2048
    s_add_u32 s86, s86, 7168
    buffer_load_dwordx4 v5, s[32:35], s86 offen lds
    s_add_u32 m0, s10, 3072
    s_add_u32 s86, s86, 7168
    buffer_load_dwordx4 v5, s[32:35], s86 offen lds
    s_and_b32 s42, s81, 3
    s_lshl_b32 s42, s42, 1
    s_add_u32 s42, s42, s38
    s_mul_i32 s42, s42, 7168
    s_mul_i32 s43, s37, 401408
    s_add_u32 s42, s42, s43
    s_lshl_b32 s43, s82, 7
    s_add_u32 s42, s42, s43
    s_add_u32 s43, s83, 4
    s_cmp_ge_u32 s43, 7
    s_cselect_b32 s17, 7, 0
    s_sub_u32 s43, s43, s17
    s_mul_i32 s43, s43, 57344
    s_add_u32 s42, s42, s43
    v_mul_u32_u24 v208, 896, v1
    s_mov_b64 exec, 0xff
    buffer_load_dword v209, v208, s[32:35], s42 offen
    s_mov_b64 exec, -1
    s_cmp_eq_u32 s40, 6
    s_cbranch_scc1 L_six
    s_branch L_phase_b
L_red:
    s_nop 9
    v_mul_f32 v144, v144, v208
    v_mul_f32 v145, v145, v209
    v_mul_f32 v146, v146, v210
    v_mul_f32 v147, v147, v211
    v_mul_f32 v148, v148, v212
    v_mul_f32 v149, v149, v213
    v_mul_f32 v150, v150, v214
    v_mul_f32 v151, v151, v215
    v_mul_f32 v152, v152, v216
    v_mul_f32 v153, v153, v217
    v_mul_f32 v154, v154, v218
    v_mul_f32 v155, v155, v219
    v_mul_f32 v156, v156, v220
    v_mul_f32 v157, v157, v221
    v_mul_f32 v158, v158, v222
    v_mul_f32 v159, v159, v223
    v_mov_b32 v176, s44
    v_mov_b32 v177, 0
    v_cvt_pk_bf16_f32 v200, v144, v145
    v_cvt_pk_bf16_f32 v201, v146, v147
    v_cvt_pk_bf16_f32 v202, v148, v149
    v_cvt_pk_bf16_f32 v203, v150, v151
    v_cvt_pk_bf16_f32 v204, v152, v153
    v_cvt_pk_bf16_f32 v205, v154, v155
    v_cvt_pk_bf16_f32 v206, v156, v157
    v_cvt_pk_bf16_f32 v207, v158, v159
    v_cndmask_b32 v200, v200, v176, s[54:55]
    v_cndmask_b32 v201, v201, v176, s[54:55]
    v_cndmask_b32 v202, v202, v176, s[54:55]
    v_cndmask_b32 v203, v203, v176, s[54:55]
    v_cndmask_b32 v204, v204, v176, s[54:55]
    v_cndmask_b32 v205, v205, v176, s[54:55]
    v_cndmask_b32 v206, v206, v176, s[54:55]
    v_cndmask_b32 v207, v207, v176, s[54:55]
    v_mfma_f32_32x32x16_bf16 v[144:159], v[192:195], v[200:203], 0
    s_nop 0
    v_mfma_f32_32x32x16_bf16 v[144:159], v[196:199], v[204:207], v[144:159]
    s_lshl_b32 s84, s37, 1
    s_add_u32 s84, s84, s38
    s_lshl_b32 s84, s84, 12
    s_add_u32 s84, s84, 65536
    v_add_u32 v6, s84, v2
    s_sub_u32 s59, s38, 1
    s_mov_b32 s58, 0
    s_sub_u32 s54, 0, s38
    s_mov_b32 s55, 0
    s_nop 2
    v_cndmask_b32 v156, v156, v177, s[58:59]
    v_cndmask_b32 v157, v157, v177, s[58:59]
    v_cndmask_b32 v158, v158, v177, s[58:59]
    v_cndmask_b32 v159, v159, v177, s[58:59]
    v_cndmask_b32 v144, v144, v177, s[54:55]
    v_cndmask_b32 v145, v145, v177, s[54:55]
    v_cndmask_b32 v146, v146, v177, s[54:55]
    v_cndmask_b32 v147, v147, v177, s[54:55]
    ds_write_b128 v6, v[144:147] offset:0
    ds_write_b128 v6, v[148:151] offset:1024
    ds_write_b128 v6, v[152:155] offset:2048
    ds_write_b128 v6, v[156:159] offset:3072
    s_waitcnt lgkmcnt(0)
    s_barrier
    s_and_b32 s42, s2, 7
    s_lshl_b32 s42, s42, 11
    s_add_u32 s42, s42, 13254656
    v_and_b32 v173, 15, v1
    v_lshl_add_u32 v173, v173, 7, s42
    buffer_load_dwordx2 v[174:175], v173, s[28:31], 0 offen sc1
    s_lshl_b32 s84, s38, 12
    s_lshl_b32 s85, s37, 10
    s_add_u32 s84, s84, s85
    s_add_u32 s84, s84, 65536
    v_add_u32 v6, s84, v2
    ds_read_b128 v[144:147], v6 offset:0
    ds_read_b128 v[148:151], v6 offset:8192
    ds_read_b128 v[152:155], v6 offset:16384
    ds_read_b128 v[156:159], v6 offset:24576
    s_waitcnt lgkmcnt(2)
    v_add_f32 v144, v144, v148
    s_waitcnt lgkmcnt(0)
    v_add_f32 v152, v152, v156
    v_add_f32 v145, v145, v149
    v_add_f32 v153, v153, v157
    v_add_f32 v146, v146, v150
    v_add_f32 v154, v154, v158
    v_add_f32 v147, v147, v151
    v_add_f32 v155, v155, v159
    v_add_f32 v144, v144, v152
    v_add_f32 v145, v145, v153
    v_add_f32 v146, v146, v154
    v_add_f32 v147, v147, v155
    buffer_store_dwordx4 v[144:147], v2, s[28:31], s75 offen sc1
    s_waitcnt vmcnt(1)
    v_subrev_u32 v224, s57, v175
    v_cmp_ne_u32 vcc, s56, v174
    v_cmp_lt_u32 s[60:61], 15, v224
    s_nop 4
    s_or_b64 vcc, vcc, s[60:61]
    s_cmp_eq_u64 vcc, 0
    s_cbranch_scc1 L_px_r_ok
    s_mov_b32 s80, 0
L_px_r_spin:
    s_add_u32 s80, s80, 1
    s_cmp_gt_u32 s80, 1048576
    s_cbranch_scc1 L_end
    buffer_load_dwordx2 v[174:175], v173, s[28:31], 0 offen sc1
    s_waitcnt vmcnt(0)
    v_subrev_u32 v224, s57, v175
    v_cmp_ne_u32 vcc, s56, v174
    v_cmp_lt_u32 s[60:61], 15, v224
    s_nop 4
    s_or_b64 vcc, vcc, s[60:61]
    s_cmp_eq_u64 vcc, 0
    s_cbranch_scc0 L_px_r_spin
L_px_r_ok:
    s_sub_u32 s84, s78, 13205504
    s_lshr_b32 s84, s84, 7
    s_lshl_b32 s42, s37, 18
    s_lshl_b32 s43, s84, 11
    s_add_u32 s42, s42, s43
    s_add_u32 s62, s42, 11534336
    s_add_u32 s63, s62, 65536
    s_add_u32 s64, s62, 131072
    s_add_u32 s65, s62, 196608
    s_lshl_b32 s43, s36, 11
    s_add_u32 s43, s43, 98304
    v_add_u32 v12, s43, v2
    s_and_b32 s86, s41, 1
    s_lshl_b32 s86, s86, 3
    s_add_u32 s86, s86, s36
    s_and_b32 s42, s2, 7
    s_lshl_b32 s42, s42, 7
    v_and_b32 v173, 31, v1
    v_lshlrev_b32 v173, 10, v173
    v_add_u32 v173, s42, v173
    v_and_b32 v174, 15, v1
    v_lshlrev_b32 v174, 7, v174
    v_add_u32 v174, 30720, v174
    v_cmp_gt_u32 vcc, 32, v1
    s_nop 1
    v_cndmask_b32 v173, v174, v173, vcc
    v_add_u32 v173, 13238272, v173
    buffer_load_dwordx2 v[174:175], v173, s[28:31], 0 offen sc1
    s_waitcnt vmcnt(0)
    v_subrev_u32 v224, s57, v175
    v_cmp_ne_u32 vcc, s56, v174
    v_cmp_lt_u32 s[60:61], 15, v224
    s_nop 4
    s_or_b64 vcc, vcc, s[60:61]
    s_cmp_eq_u64 vcc, 0
    s_cbranch_scc1 L_px_g_ok
    s_mov_b32 s80, 0
L_px_g_spin:
    s_add_u32 s80, s80, 1
    s_cmp_gt_u32 s80, 1048576
    s_cbranch_scc1 L_end
    buffer_load_dwordx2 v[174:175], v173, s[28:31], 0 offen sc1
    s_waitcnt vmcnt(0)
    v_subrev_u32 v224, s57, v175
    v_cmp_ne_u32 vcc, s56, v174
    v_cmp_lt_u32 s[60:61], 15, v224
    s_nop 4
    s_or_b64 vcc, vcc, s[60:61]
    s_cmp_eq_u64 vcc, 0
    s_cbranch_scc0 L_px_g_spin
L_px_g_ok:
    v_cmp_ne_u32 vcc, s79, v175
    s_nop 4
    s_cmp_eq_u32 vcc_lo, 0
    s_cselect_b32 s79, 1, 0
    buffer_load_dwordx4 v[16:19], v2, s[28:31], s62 offen offset:0 sc1
    buffer_load_dwordx4 v[20:23], v2, s[28:31], s62 offen offset:1024 sc1
    buffer_load_dwordx4 v[24:27], v2, s[28:31], s63 offen offset:0 sc1
    buffer_load_dwordx4 v[28:31], v2, s[28:31], s63 offen offset:1024 sc1
    buffer_load_dwordx4 v[32:35], v2, s[28:31], s64 offen offset:0 sc1
    buffer_load_dwordx4 v[36:39], v2, s[28:31], s64 offen offset:1024 sc1
    buffer_load_dwordx4 v[40:43], v2, s[28:31], s65 offen offset:0 sc1
    buffer_load_dwordx4 v[44:47], v2, s[28:31], s65 offen offset:1024 sc1
    s_waitcnt vmcnt(7)
    v_max3_u32 v224, v16, v17, v18
    s_waitcnt vmcnt(6)
    v_max3_u32 v224, v224, v19, v20
    v_max3_u32 v224, v224, v21, v22
    s_waitcnt vmcnt(5)
    v_max3_u32 v224, v224, v23, v24
    v_max3_u32 v224, v224, v25, v26
    s_waitcnt vmcnt(4)
    v_max3_u32 v224, v224, v27, v28
    v_max3_u32 v224, v224, v29, v30
    s_waitcnt vmcnt(3)
    v_max3_u32 v224, v224, v31, v32
    v_max3_u32 v224, v224, v33, v34
    s_waitcnt vmcnt(2)
    v_max3_u32 v224, v224, v35, v36
    v_max3_u32 v224, v224, v37, v38
    s_waitcnt vmcnt(1)
    v_max3_u32 v224, v224, v39, v40
    v_max3_u32 v224, v224, v41, v42
    s_waitcnt vmcnt(0)
    v_max3_u32 v224, v224, v43, v44
    v_max3_u32 v224, v224, v45, v46
    v_max3_u32 v224, v224, v47, v47
    v_cmp_eq_u32 vcc, -1, v224
    s_nop 4
    s_cmp_eq_u64 vcc, 0
    s_cbranch_scc1 L_fk_ok
    s_mov_b32 s80, 0
L_fk_spin:
    s_add_u32 s80, s80, 1
    s_cmp_gt_u32 s80, 1048576
    s_cbranch_scc1 L_end
    s_sleep 1
    buffer_load_dwordx4 v[16:19], v2, s[28:31], s62 offen offset:0 sc1
    buffer_load_dwordx4 v[20:23], v2, s[28:31], s62 offen offset:1024 sc1
    buffer_load_dwordx4 v[24:27], v2, s[28:31], s63 offen offset:0 sc1
    buffer_load_dwordx4 v[28:31], v2, s[28:31], s63 offen offset:1024 sc1
    buffer_load_dwordx4 v[32:35], v2, s[28:31], s64 offen offset:0 sc1
    buffer_load_dwordx4 v[36:39], v2, s[28:31], s64 offen offset:1024 sc1
    buffer_load_dwordx4 v[40:43], v2, s[28:31], s65 offen offset:0 sc1
    buffer_load_dwordx4 v[44:47], v2, s[28:31], s65 offen offset:1024 sc1
    s_waitcnt vmcnt(0)
    v_max3_u32 v224, v16, v17, v18
    v_max3_u32 v224, v224, v19, v20
    v_max3_u32 v224, v224, v21, v22
    v_max3_u32 v224, v224, v23, v24
    v_max3_u32 v224, v224, v25, v26
    v_max3_u32 v224, v224, v27, v28
    v_max3_u32 v224, v224, v29, v30
    v_max3_u32 v224, v224, v31, v32
    v_max3_u32 v224, v224, v33, v34
    v_max3_u32 v224, v224, v35, v36
    v_max3_u32 v224, v224, v37, v38
    v_max3_u32 v224, v224, v39, v40
    v_max3_u32 v224, v224, v41, v42
    v_max3_u32 v224, v224, v43, v44
    v_max3_u32 v224, v224, v45, v46
    v_max3_u32 v224, v224, v47, v47
    v_cmp_eq_u32 vcc, -1, v224
    s_nop 4
    s_cmp_eq_u64 vcc, 0
    s_cbranch_scc0 L_fk_spin
L_fk_ok:
    v_add_f32 v16, v16, v24
    v_add_f32 v32, v32, v40
    v_add_f32 v17, v17, v25
    v_add_f32 v33, v33, v41
    v_add_f32 v18, v18, v26
    v_add_f32 v34, v34, v42
    v_add_f32 v19, v19, v27
    v_add_f32 v35, v35, v43
    v_add_f32 v20, v20, v28
    v_add_f32 v36, v36, v44
    v_add_f32 v21, v21, v29
    v_add_f32 v37, v37, v45
    v_add_f32 v22, v22, v30
    v_add_f32 v38, v38, v46
    v_add_f32 v23, v23, v31
    v_add_f32 v39, v39, v47
    v_add_f32 v16, v16, v32
    v_add_f32 v17, v17, v33
    v_add_f32 v18, v18, v34
    v_add_f32 v19, v19, v35
    v_add_f32 v20, v20, v36
    v_add_f32 v21, v21, v37
    v_add_f32 v22, v22, v38
    v_add_f32 v23, v23, v39
    ds_write_b128 v12, v[16:19] offset:0
    ds_write_b128 v12, v[20:23] offset:1024
    s_waitcnt lgkmcnt(0)
    s_barrier
    s_cmp_lg_u32 s37, 0
    s_cbranch_scc1 L_red_rest
    ds_read_b128 v[16:19], v12 offset:0
    ds_read_b128 v[20:23], v12 offset:1024
    ds_read_b128 v[24:27], v12 offset:2048
    ds_read_b128 v[28:31], v12 offset:3072
    ds_read_b128 v[32:35], v12 offset:4096
    ds_read_b128 v[36:39], v12 offset:5120
    ds_read_b128 v[40:43], v12 offset:6144
    ds_read_b128 v[44:47], v12 offset:7168
    s_lshl_b32 s42, s84, 10
    s_add_u32 s42, s42, 12582912
    s_waitcnt lgkmcnt(3)
    v_add_f32 v16, v16, v32
    v_add_f32 v17, v17, v33
    v_add_f32 v18, v18, v34
    v_add_f32 v19, v19, v35
    s_waitcnt lgkmcnt(2)
    v_add_f32 v20, v20, v36
    v_add_f32 v21, v21, v37
    v_add_f32 v22, v22, v38
    v_add_f32 v23, v23, v39
    s_waitcnt lgkmcnt(1)
    v_add_f32 v24, v24, v40
    v_add_f32 v25, v25, v41
    v_add_f32 v26, v26, v42
    v_add_f32 v27, v27, v43
    s_waitcnt lgkmcnt(0)
    v_add_f32 v28, v28, v44
    v_add_f32 v29, v29, v45
    v_add_f32 v30, v30, v46
    v_add_f32 v31, v31, v47
    v_add_f32 v16, v16, v24
    v_add_f32 v17, v17, v25
    v_add_f32 v18, v18, v26
    v_add_f32 v19, v19, v27
    v_add_f32 v20, v20, v28
    v_add_f32 v21, v21, v29
    v_add_f32 v22, v22, v30
    v_add_f32 v23, v23, v31
    v_cvt_pk_bf16_f32 v48, v16, v17
    v_cvt_pk_bf16_f32 v49, v18, v19
    v_cvt_pk_bf16_f32 v50, v20, v21
    v_cvt_pk_bf16_f32 v51, v22, v23
    buffer_store_dwordx4 v[48:51], v2, s[28:31], s42 offen sc1
L_red_rest:
L_att:
    s_lshl_b32 s42, s81, 1
    s_add_u32 s42, s42, s38
    s_lshl_b32 s76, s42, 7
    s_lshl_b32 s43, s37, 3
    s_add_u32 s76, s76, s43
    s_add_u32 s76, s76, 13123584
    s_mul_i32 s50, s42, 143360
    s_lshl_b32 s42, s42, 8
    s_add_u32 s42, s42, 13107200
    v_and_b32 v173, 31, v1
    v_lshl_add_u32 v173, v173, 3, s42
    s_mul_i32 s42, s37, 7168
    s_add_u32 s50, s50, s42
    s_add_u32 s50, s50, 114688
    s_add_u32 s51, s50, 4096
    s_lshl_b32 s55, s37, 13
    s_add_u32 s55, s55, 12582912
    s_add_u32 s54, s55, 4096
    s_mul_i32 s42, s37, 7
    s_lshr_b32 s43, s42, 2
    s_add_u32 s42, s42, 6
    s_lshr_b32 s42, s42, 2
    s_add_u32 s42, s42, 1
    s_lshl_b32 s42, s42, 1
    s_lshl_b32 s43, s43, 1
    s_lshl_b32 s42, 1, s42
    s_lshl_b32 s43, 1, s43
    s_sub_u32 s58, s42, s43
    s_mov_b32 s59, 0
    s_mov_b32 s60, 0
    s_mov_b32 s61, -1
    s_lshl_b32 s42, s38, 12
    s_add_u32 s55, s55, s42
    s_lshl_b32 s54, s37, 13
    s_add_u32 s54, s54, 98304
    v_add_u32 v3, s54, v2
    s_add_u32 s54, s54, s42
    s_mov_b32 m0, s54
    s_barrier
    buffer_load_dwordx4 v2, s[28:31], s55 offen offset:0 sc1 lds
    buffer_load_dwordx4 v2, s[28:31], s55 offen offset:1024 sc1 lds
    buffer_load_dwordx4 v2, s[28:31], s55 offen offset:2048 sc1 lds
    buffer_load_dwordx4 v2, s[28:31], s55 offen offset:3072 sc1 lds
    s_mov_b32 s80, 0
    s_waitcnt vmcnt(0)
L_kv_try:
    s_barrier
    ds_read_b128 v[68:71], v3 offset:0
    ds_read_b128 v[72:75], v3 offset:1024
    ds_read_b128 v[76:79], v3 offset:2048
    ds_read_b128 v[80:83], v3 offset:3072
    ds_read_b128 v[84:87], v3 offset:4096
    ds_read_b128 v[88:91], v3 offset:5120
    ds_read_b128 v[92:95], v3 offset:6144
    ds_read_b128 v[96:99], v3 offset:7168
    s_waitcnt lgkmcnt(0)
    v_max3_u32 v16, v68, v69, v70
    v_max3_u32 v16, v16, v71, v72
    v_max3_u32 v16, v16, v73, v74
    v_max3_u32 v16, v16, v75, v76
    v_max3_u32 v16, v16, v77, v78
    v_max3_u32 v16, v16, v79, v80
    v_max3_u32 v16, v16, v81, v82
    v_max3_u32 v16, v16, v83, v84
    v_max3_u32 v16, v16, v85, v86
    v_max3_u32 v16, v16, v87, v88
    v_max3_u32 v16, v16, v89, v90
    v_max3_u32 v16, v16, v91, v92
    v_max3_u32 v16, v16, v93, v94
    v_max3_u32 v16, v16, v95, v96
    v_max3_u32 v16, v16, v97, v98
    v_max3_u32 v16, v16, v99, v99
    v_cmp_eq_u32 vcc, -1, v16
    s_nop 4
    s_cmp_eq_u64 vcc, 0
    s_cselect_b32 s42, 0, 1
    v_mov_b32 v16, s42
    v_mov_b32 v17, s36
    v_lshlrev_b32 v17, 2, v17
    ds_write_b32 v17, v16
    s_waitcnt lgkmcnt(0)
    s_barrier
    v_and_b32 v17, 7, v1
    v_lshlrev_b32 v17, 2, v17
    ds_read_b32 v16, v17
    s_waitcnt lgkmcnt(0)
    v_cmp_ne_u32 vcc, 0, v16
    s_nop 4
    s_cmp_eq_u64 vcc, 0
    s_cbranch_scc1 L_kv_ok
    s_add_u32 s80, s80, 1
    s_cmp_gt_u32 s80, 1048576
    s_cbranch_scc1 L_end
    s_sleep 4
    s_barrier
    buffer_load_dwordx4 v2, s[28:31], s55 offen offset:0 sc1 lds
    buffer_load_dwordx4 v2, s[28:31], s55 offen offset:1024 sc1 lds
    buffer_load_dwordx4 v2, s[28:31], s55 offen offset:2048 sc1 lds
    buffer_load_dwordx4 v2, s[28:31], s55 offen offset:3072 sc1 lds
    s_waitcnt vmcnt(0)
    s_branch L_kv_try
L_kv_ok:
    buffer_load_dwordx2 v[174:175], v173, s[28:31], 0 offen sc1
    s_waitcnt vmcnt(0)
    v_cmp_ne_u64 vcc, s[56:57], v[174:175]
    s_nop 4
    s_and_b64 vcc, vcc, s[58:59]
    s_cmp_eq_u64 vcc, 0
    s_cbranch_scc1 L_fq_ok
    s_mov_b32 s80, 0
L_fq_spin:
    s_add_u32 s80, s80, 1
    s_cmp_gt_u32 s80, 1048576
    s_cbranch_scc1 L_end
    s_sleep 2
    buffer_load_dwordx2 v[174:175], v173, s[28:31], 0 offen sc1
    s_waitcnt vmcnt(0)
    v_cmp_ne_u64 vcc, s[56:57], v[174:175]
    s_nop 4
    s_and_b64 vcc, vcc, s[58:59]
    s_cmp_eq_u64 vcc, 0
    s_cbranch_scc0 L_fq_spin
L_fq_ok:
    s_cmp_eq_u32 s79, 1
    s_cbranch_scc1 L_noinv_fq
    buffer_inv sc1
    s_waitcnt vmcnt(0)
L_noinv_fq:
    buffer_load_dwordx4 v[40:43], v2, s[28:31], s50 offen offset:0 sc1
    buffer_load_dwordx4 v[44:47], v2, s[28:31], s50 offen offset:1024 sc1
    buffer_load_dwordx4 v[48:51], v2, s[28:31], s50 offen offset:2048 sc1
    buffer_load_dwordx4 v[52:55], v2, s[28:31], s50 offen offset:3072 sc1
    buffer_load_dwordx4 v[56:59], v2, s[28:31], s51 offen offset:0 sc1
    buffer_load_dwordx4 v[60:63], v2, s[28:31], s51 offen offset:1024 sc1
    buffer_load_dwordx4 v[64:67], v2, s[28:31], s51 offen offset:2048 sc1
    s_waitcnt vmcnt(6)
    v_mfma_f32_32x32x16_bf16 v[192:207], v[68:71], v[40:43], 0
    s_waitcnt vmcnt(4)
    v_mfma_f32_32x32x16_bf16 v[208:223], v[76:79], v[46:49], 0
    v_mfma_f32_32x32x16_bf16 v[192:207], v[72:75], v[44:47], v[192:207]
    s_waitcnt vmcnt(3)
    v_mfma_f32_32x32x16_bf16 v[208:223], v[80:83], v[50:53], v[208:223]
    s_nop 9
    v_mov_b32 v20, v204
    s_nop 0
    v_mov_b32 v21, v208
    v_permlane32_swap_b32 v204, v20
    s_nop 0
    v_permlane32_swap_b32 v21, v208
    v_add_f32 v20, 0x358637bd, v20
    v_add_f32 v21, 0x358637bd, v21
    v_rcp_f32 v20, v20
    v_rcp_f32 v21, v21
    s_nop 0
    v_pk_mul_f32 v[192:193], v[192:193], v[20:21] op_sel:[0,0] op_sel_hi:[1,0]
    v_pk_mul_f32 v[194:195], v[194:195], v[20:21] op_sel:[0,0] op_sel_hi:[1,0]
    v_pk_mul_f32 v[196:197], v[196:197], v[20:21] op_sel:[0,0] op_sel_hi:[1,0]
    v_pk_mul_f32 v[198:199], v[198:199], v[20:21] op_sel:[0,0] op_sel_hi:[1,0]
    v_pk_mul_f32 v[200:201], v[200:201], v[20:21] op_sel:[0,0] op_sel_hi:[1,0]
    v_pk_mul_f32 v[202:203], v[202:203], v[20:21] op_sel:[0,0] op_sel_hi:[1,0]
    v_pk_mul_f32 v[204:205], v[204:205], v[20:21] op_sel:[0,0] op_sel_hi:[1,0]
    v_pk_mul_f32 v[206:207], v[206:207], v[20:21] op_sel:[0,0] op_sel_hi:[1,0]
    v_pk_mul_f32 v[208:209], v[208:209], v[20:21] op_sel:[0,1] op_sel_hi:[1,1]
    v_pk_mul_f32 v[210:211], v[210:211], v[20:21] op_sel:[0,1] op_sel_hi:[1,1]
    v_pk_mul_f32 v[212:213], v[212:213], v[20:21] op_sel:[0,1] op_sel_hi:[1,1]
    v_pk_mul_f32 v[214:215], v[214:215], v[20:21] op_sel:[0,1] op_sel_hi:[1,1]
    v_pk_mul_f32 v[216:217], v[216:217], v[20:21] op_sel:[0,1] op_sel_hi:[1,1]
    v_pk_mul_f32 v[218:219], v[218:219], v[20:21] op_sel:[0,1] op_sel_hi:[1,1]
    v_pk_mul_f32 v[220:221], v[220:221], v[20:21] op_sel:[0,1] op_sel_hi:[1,1]
    v_pk_mul_f32 v[222:223], v[222:223], v[20:21] op_sel:[0,1] op_sel_hi:[1,1]
    v_cvt_pk_bf16_f32 v100, v192, v193
    v_cvt_pk_bf16_f32 v101, v194, v195
    v_cvt_pk_bf16_f32 v102, v196, v197
    v_cvt_pk_bf16_f32 v103, v198, v199
    v_cvt_pk_bf16_f32 v104, v200, v201
    v_cvt_pk_bf16_f32 v105, v202, v203
    v_cvt_pk_bf16_f32 v16, v204, v205
    v_cvt_pk_bf16_f32 v18, v208, v209
    v_cvt_pk_bf16_f32 v17, v206, v207
    v_cvt_pk_bf16_f32 v19, v210, v211
    v_cndmask_b32 v106, v16, v18, s[60:61]
    v_cndmask_b32 v107, v17, v19, s[60:61]
    v_cvt_pk_bf16_f32 v108, v212, v213
    v_cvt_pk_bf16_f32 v109, v214, v215
    v_cvt_pk_bf16_f32 v110, v216, v217
    v_cvt_pk_bf16_f32 v111, v218, v219
    v_cvt_pk_bf16_f32 v112, v220, v221
    v_cvt_pk_bf16_f32 v113, v222, v223
    buffer_store_dwordx4 v[100:103], v2, s[28:31], s50 offen offset:0
    buffer_store_dwordx4 v[104:107], v2, s[28:31], s50 offen offset:1024
    buffer_store_dwordx4 v[108:111], v2, s[28:31], s50 offen offset:2048
    s_waitcnt vmcnt(5)
    v_mfma_f32_32x32x16_bf16 v[192:207], v[84:87], v[54:57], 0
    s_waitcnt vmcnt(4)
    v_mfma_f32_32x32x16_bf16 v[208:223], v[92:95], v[60:63], 0
    v_mfma_f32_32x32x16_bf16 v[192:207], v[88:91], v[58:61], v[192:207]
    s_waitcnt vmcnt(3)
    v_mfma_f32_32x32x16_bf16 v[208:223], v[96:99], v[64:67], v[208:223]
    s_nop 9
    v_mov_b32 v20, v204
    s_nop 0
    v_mov_b32 v21, v208
    v_permlane32_swap_b32 v204, v20
    s_nop 0
    v_permlane32_swap_b32 v21, v208
    v_add_f32 v20, 0x358637bd, v20
    v_add_f32 v21, 0x358637bd, v21
    v_rcp_f32 v20, v20
    v_rcp_f32 v21, v21
    s_nop 0
    v_pk_mul_f32 v[192:193], v[192:193], v[20:21] op_sel:[0,0] op_sel_hi:[1,0]
    v_pk_mul_f32 v[194:195], v[194:195], v[20:21] op_sel:[0,0] op_sel_hi:[1,0]
    v_pk_mul_f32 v[196:197], v[196:197], v[20:21] op_sel:[0,0] op_sel_hi:[1,0]
    v_pk_mul_f32 v[198:199], v[198:199], v[20:21] op_sel:[0,0] op_sel_hi:[1,0]
    v_pk_mul_f32 v[200:201], v[200:201], v[20:21] op_sel:[0,0] op_sel_hi:[1,0]
    v_pk_mul_f32 v[202:203], v[202:203], v[20:21] op_sel:[0,0] op_sel_hi:[1,0]
    v_pk_mul_f32 v[204:205], v[204:205], v[20:21] op_sel:[0,0] op_sel_hi:[1,0]
    v_pk_mul_f32 v[206:207], v[206:207], v[20:21] op_sel:[0,0] op_sel_hi:[1,0]
    v_pk_mul_f32 v[208:209], v[208:209], v[20:21] op_sel:[0,1] op_sel_hi:[1,1]
    v_pk_mul_f32 v[210:211], v[210:211], v[20:21] op_sel:[0,1] op_sel_hi:[1,1]
    v_pk_mul_f32 v[212:213], v[212:213], v[20:21] op_sel:[0,1] op_sel_hi:[1,1]
    v_pk_mul_f32 v[214:215], v[214:215], v[20:21] op_sel:[0,1] op_sel_hi:[1,1]
    v_pk_mul_f32 v[216:217], v[216:217], v[20:21] op_sel:[0,1] op_sel_hi:[1,1]
    v_pk_mul_f32 v[218:219], v[218:219], v[20:21] op_sel:[0,1] op_sel_hi:[1,1]
    v_pk_mul_f32 v[220:221], v[220:221], v[20:21] op_sel:[0,1] op_sel_hi:[1,1]
    v_pk_mul_f32 v[222:223], v[222:223], v[20:21] op_sel:[0,1] op_sel_hi:[1,1]
    v_cvt_pk_bf16_f32 v114, v192, v193
    v_cvt_pk_bf16_f32 v115, v194, v195
    v_cvt_pk_bf16_f32 v116, v196, v197
    v_cvt_pk_bf16_f32 v117, v198, v199
    v_cvt_pk_bf16_f32 v118, v200, v201
    v_cvt_pk_bf16_f32 v119, v202, v203
    v_cvt_pk_bf16_f32 v16, v204, v205
    v_cvt_pk_bf16_f32 v18, v208, v209
    v_cvt_pk_bf16_f32 v17, v206, v207
    v_cvt_pk_bf16_f32 v19, v210, v211
    v_cndmask_b32 v120, v16, v18, s[60:61]
    v_cndmask_b32 v121, v17, v19, s[60:61]
    v_cvt_pk_bf16_f32 v122, v212, v213
    v_cvt_pk_bf16_f32 v123, v214, v215
    v_cvt_pk_bf16_f32 v124, v216, v217
    v_cvt_pk_bf16_f32 v125, v218, v219
    v_cvt_pk_bf16_f32 v126, v220, v221
    v_cvt_pk_bf16_f32 v127, v222, v223
    buffer_store_dwordx4 v[112:115], v2, s[28:31], s50 offen offset:3072
    buffer_store_dwordx4 v[116:119], v2, s[28:31], s51 offen offset:0
    buffer_store_dwordx4 v[120:123], v2, s[28:31], s51 offen offset:1024
    buffer_store_dwordx4 v[124:127], v2, s[28:31], s51 offen offset:2048
    v_mov_b32 v224, s56
    v_mov_b32 v225, s57
    v_mov_b32 v226, 0
    s_waitcnt vmcnt(0)
    s_mov_b64 exec, 1
    s_cmp_eq_u32 s79, 1
    s_cbranch_scc1 L_fast_o
    buffer_wbl2 sc1
    s_waitcnt vmcnt(0)
    buffer_store_dwordx2 v[224:225], v226, s[28:31], s76 offen sc1
    s_branch L_pub_o
L_fast_o:
    buffer_store_dwordx2 v[224:225], v226, s[28:31], s76 offen
L_pub_o:
    s_mov_b64 exec, -1
    s_waitcnt vmcnt(0)
    s_barrier
    s_and_b32 s86, s41, 3
    s_lshl_b32 s86, s86, 3
    s_add_u32 s86, s86, s36
    s_mov_b32 s32, s100
    s_mov_b32 s33, s101
    s_mov_b32 s34, 1605632
    s_mov_b32 s35, 0x20000
    s_mov_b32 s88, s8
    s_mov_b32 s89, s9
    s_mov_b32 s90, 401408
    s_mov_b32 s91, 0x20000
    v_mul_u32_u24 v60, 896, v1
    s_mov_b32 s62, s86
    s_mov_b32 exec_hi, 0xffff
L_st1:
    s_lshr_b32 s64, s62, 2
    s_lshl_b32 s64, s64, 7
    s_and_b32 s63, s62, 3
    s_mul_i32 s63, s63, 100352
    s_add_u32 s64, s64, s63
    s_add_u32 s64, s64, 57344
    buffer_load_dword v61, v60, s[88:91], s64 offen
    s_add_u32 s62, s62, 32
    s_cmp_lt_u32 s62, 28
    s_cbranch_scc1 L_st1
    s_mov_b64 exec, -1
    s_mov_b32 s62, s86
L_st2:
    s_lshr_b32 s63, s62, 2
    s_add_u32 s64, s63, 5
    s_cmp_ge_u32 s64, 7
    s_cselect_b32 s17, 7, 0
    s_sub_u32 s64, s64, s17
    s_mul_i32 s64, s64, 57344
    s_lshl_b32 s63, s63, 7
    s_add_u32 s64, s64, s63
    s_and_b32 s63, s62, 3
    s_mul_i32 s63, s63, 401408
    s_add_u32 s64, s64, s63
    buffer_load_dword v61, v60, s[32:35], s64 offen
    s_add_u32 s62, s62, 32
    s_cmp_lt_u32 s62, 28
    s_cbranch_scc1 L_st2
    s_mov_b32 s62, s86
L_st3:
    s_lshr_b32 s63, s62, 2
    s_add_u32 s64, s63, 6
    s_cmp_ge_u32 s64, 7
    s_cselect_b32 s17, 7, 0
    s_sub_u32 s64, s64, s17
    s_mul_i32 s64, s64, 57344
    s_lshl_b32 s63, s63, 7
    s_add_u32 s64, s64, s63
    s_and_b32 s63, s62, 3
    s_mul_i32 s63, s63, 401408
    s_add_u32 s64, s64, s63
    buffer_load_dword v61, v60, s[32:35], s64 offen
    s_add_u32 s62, s62, 32
    s_cmp_lt_u32 s62, 28
    s_cbranch_scc1 L_st3
    s_endpgm
L_six:
    s_waitcnt vmcnt(0)
    s_barrier
    s_and_b32 s86, s41, 1
    s_lshl_b32 s86, s86, 3
    s_add_u32 s86, s86, s36
    s_waitcnt vmcnt(0)
    s_branch L_att
L_end:
    s_endpgm
.section .rodata,"a"
.p2align 6
.amdhsa_kernel recurrent_scan__linear_attn_block__dense_activation_silu__prompt_kernel
  .amdhsa_next_free_vgpr 256
  .amdhsa_next_free_sgpr 102
  .amdhsa_accum_offset 228
  .amdhsa_group_segment_fixed_size 0
  .amdhsa_kernarg_size 72
  .amdhsa_user_sgpr_count 2
  .amdhsa_user_sgpr_kernarg_segment_ptr 1
  .amdhsa_system_sgpr_workgroup_id_x 1
  .amdhsa_float_denorm_mode_32 3
.end_amdhsa_kernel
```
